```python
import torch

def _softmax(x, axis=-1):
    return torch.softmax(x, dim=axis)
def _gelu(x):
    return torch.nn.functional.gelu(x, approximate="tanh")
def _silu(x):
    return torch.nn.functional.silu(x)
def _sigmoid(x):
    return torch.sigmoid(x)
def _layernorm(x, axis=-1, eps=1e-5):
    m = x.mean(dim=axis, keepdim=True)
    v = x.var(dim=axis, keepdim=True, unbiased=False)
    return (x - m) / torch.sqrt(v + eps)
def _scatter_add(tgt, idx, src, axis=0):
    return tgt.clone().index_add_(axis, idx, src)
def _segment_sum(src, seg, n):
    out = torch.zeros((n,) + src.shape[1:], dtype=src.dtype)
    return out.index_add_(0, seg, src)
def _pad(x, pw):
    flat = tuple(v for pair in reversed(pw) for v in pair)
    return torch.nn.functional.pad(x, flat)

kernel_name = 'standalone__gqa_block_cached__sampling'

def setup_inputs():

    _w = (lambda a: (lambda t: t.to(torch.bfloat16) if t.is_floating_point() else t)(torch.as_tensor(a)))
    B, Sq, D = 32, 32, 576
    Hq, Hkv, Sk, Dh = 32, 16, 2048, 128
    assert Hq % Hkv == 0, (Hq, Hkv)
    return {
        "x": _w((lambda *s: torch.randn(*s, dtype=torch.bfloat16) * 0.8)(B, Sq, D)),
        "k_cache": _w((lambda *s: torch.randn(*s, dtype=torch.bfloat16) * 0.8)(B, Hkv, Sk, Dh)),
        "v_cache": _w((lambda *s: torch.randn(*s, dtype=torch.bfloat16) * 0.05)(B, Hkv, Sk, Dh)),
        "wq": _w((lambda *s: torch.randn(*s, dtype=torch.bfloat16) * 0.8)(D, Hq * Dh) * (D ** -0.5)),
        "wo": _w((lambda *s: torch.randn(*s, dtype=torch.bfloat16) * 0.05)(Hq * Dh, D) * ((Hq * Dh) ** -0.5)),
    }

def reference(x, k_cache, v_cache, wq, wo):
    B, Sq, D = x.shape
    Hq, Dh = 32, 128
    Hkv = k_cache.shape[1]
    rep = Hq // Hkv
    q = (lambda x, *d: x.permute(*d))((x @ wq).reshape(B, Sq, Hq, Dh), 0, 2, 1, 3)
    k = (lambda x, n, axis: torch.repeat_interleave(x, n, dim=axis))(k_cache, rep, axis=1)
    v = (lambda x, n, axis: torch.repeat_interleave(x, n, dim=axis))(v_cache, rep, axis=1)
    scores = torch.einsum("bhqd,bhkd->bhqk", q, k) * (Dh ** -0.5)
    p = _softmax(scores, axis=-1)
    o = torch.einsum("bhqk,bhkd->bhqd", p, v)
    return (lambda x, *d: x.permute(*d))(o, 0, 2, 1, 3).reshape(B, Sq, Hq * Dh) @ wo
```

```asm
; @launch grid=(256,1,1) block=(256,1,1) lds=163840
.amdgcn_target "amdgcn-amd-amdhsa--gfx950"
.text
.globl standalone__gqa_block_cached__sampling_kernel
.p2align 8
.type standalone__gqa_block_cached__sampling_kernel,@function
standalone__gqa_block_cached__sampling_kernel:
    s_cmp_ge_u32 s2, 256
    s_cbranch_scc1 L_END
    s_load_dwordx16 s[4:19], s[0:1], 0
    s_memrealtime s[68:69]
    v_lshrrev_b32 v1, 6, v0
    v_and_b32 v0, 63, v0
    v_readfirstlane_b32 s52, v1
    s_lshr_b32 s53, s2, 3
    s_and_b32 s54, s2, 7
    v_lshrrev_b32 v16, 4, v0
    v_and_b32 v17, 15, v0
    v_lshrrev_b32 v18, 5, v0
    v_and_b32 v3, 31, v0
    v_lshlrev_b32 v3, 4, v3
    v_lshl_add_u32 v3, v18, 13, v3
    s_lshr_b32 s65, s52, 1
    v_and_b32 v1, 1, v0
    v_xor_b32 v1, s65, v1
    v_lshl_add_u32 v1, v16, 1, v1
    v_lshlrev_b32 v1, 4, v1
    v_lshrrev_b32 v2, 1, v17
    v_mul_u32_u24 v2, 1152, v2
    v_add_u32 v255, v1, v2
    s_lshl_b32 s71, s52, 12
    s_mul_i32 s96, s52, 9216
    s_add_u32 s96, s96, 98304
    s_mul_i32 s66, s53, 147456
    s_lshl_b32 s64, s54, 10
    s_add_u32 s66, s66, s64
    s_lshl_b32 s64, s52, 14
    s_add_u32 s66, s66, s64
    s_mul_i32 s67, s53, 36864
    s_mul_i32 s64, s52, 9216
    s_add_u32 s67, s67, s64
    s_waitcnt lgkmcnt(0)
    s_mov_b32 s28, s10
    s_mov_b32 s29, s11
    s_mov_b32 s30, 0x480000
    s_mov_b32 s31, 0x20000
    s_mov_b32 s36, s4
    s_mov_b32 s37, s5
    s_mov_b32 s38, 0x120000
    s_mov_b32 s39, 0x20000
    buffer_load_dwordx4 v[64:67], v3, s[28:31], s66 offen
    s_add_u32 s66, s66, 65536
    buffer_load_dwordx4 v[68:71], v3, s[28:31], s66 offen
    s_add_u32 s66, s66, 65536
    buffer_load_dwordx4 v[72:75], v3, s[28:31], s66 offen
    s_add_u32 m0, s96, 0
    s_nop 0
    buffer_load_dwordx4 v255, s[36:39], s67 offen offset:0 lds
    s_add_u32 m0, s96, 896
    s_nop 0
    buffer_load_dwordx4 v255, s[36:39], s67 offen offset:128 lds
    s_add_u32 m0, s96, 1792
    s_nop 0
    buffer_load_dwordx4 v255, s[36:39], s67 offen offset:256 lds
    s_add_u32 m0, s96, 2688
    s_nop 0
    buffer_load_dwordx4 v255, s[36:39], s67 offen offset:384 lds
    s_add_u32 m0, s96, 3584
    s_nop 0
    buffer_load_dwordx4 v255, s[36:39], s67 offen offset:512 lds
    s_add_u32 m0, s96, 4480
    s_nop 0
    buffer_load_dwordx4 v255, s[36:39], s67 offen offset:640 lds
    s_add_u32 m0, s96, 5376
    s_nop 0
    buffer_load_dwordx4 v255, s[36:39], s67 offen offset:768 lds
    s_add_u32 m0, s96, 6272
    s_nop 0
    buffer_load_dwordx4 v255, s[36:39], s67 offen offset:896 lds
    s_add_u32 m0, s96, 7168
    s_nop 0
    buffer_load_dwordx4 v255, s[36:39], s67 offen offset:1024 lds
    s_mov_b32 s20, s6
    s_mov_b32 s21, s7
    s_mov_b32 s22, 0x10000000
    s_mov_b32 s23, 0x20000
    s_mov_b32 s24, s8
    s_mov_b32 s25, s9
    s_mov_b32 s26, 0x10000000
    s_mov_b32 s27, 0x20000
    v_xor_b32 v3, v16, v17
    v_lshlrev_b32 v3, 4, v3
    v_lshl_add_u32 v232, v16, 8, v3
    v_xor_b32 v233, 64, v232
    v_xor_b32 v234, 128, v232
    v_xor_b32 v235, 192, v232
    v_lshlrev_b32 v3, 2, v16
    v_xor_b32 v3, v3, v17
    v_lshlrev_b32 v3, 4, v3
    v_lshl_add_u32 v236, v16, 8, v3
    s_lshl_b32 s55, s2, 20
    s_add_u32 s55, s55, s71
    s_mov_b32 s56, s71
    s_mov_b32 s57, 0
    s_mov_b32 s32, s12
    s_mov_b32 s33, s13
    s_mov_b32 s34, 0x480000
    s_mov_b32 s35, 0x20000
    s_mov_b32 s40, s14
    s_mov_b32 s41, s15
    s_mov_b32 s42, 0x120000
    s_mov_b32 s43, 0x20000
    s_mov_b32 s44, s16
    s_mov_b32 s45, s17
    s_mov_b32 s46, 0x100
    s_mov_b32 s47, 0x20000
    s_mov_b32 s48, s18
    s_mov_b32 s49, s19
    s_mov_b32 s50, 0x4000000
    s_mov_b32 s51, 0x20000
    s_or_b32 s68, s68, 1
    s_or_b32 s64, s2, s52
    s_lshl_b32 s64, s64, 12
    v_mov_b32 v244, s68
    v_mov_b32 v245, s69
    v_mov_b32 v246, s64
    s_mov_b64 exec, 1
    buffer_store_dwordx2 v[244:245], v246, s[44:47], 0 offen sc1
    s_mov_b64 exec, -1
    v_mov_b32 v246, s71
    v_and_b32 v1, 1, v16
    v_lshlrev_b32 v1, 2, v1
    v_and_b32 v2, 7, v0
    v_xor_b32 v1, v1, v2
    v_lshlrev_b32 v1, 4, v1
    v_lshrrev_b32 v2, 3, v0
    v_lshl_add_u32 v237, v2, 13, v1
    s_lshl_b32 s62, s54, 10
    s_lshl_b32 s64, s52, 7
    s_add_u32 s62, s62, s64
    s_and_b32 s64, s52, 1
    s_lshl_b32 s64, s64, 6
    v_lshlrev_b32 v3, 4, v0
    v_xor_b32 v238, s64, v3
    v_xor_b32 v239, 32, v238
    v_cmp_gt_u32 vcc, 16, v0
    s_nop 1
    v_cndmask_b32 v240, v239, v238, vcc
    s_xor_b32 s64, s52, 2
    s_mul_i32 s97, s64, 9216
    s_add_u32 s97, s97, 98304
    s_mov_b32 s60, 0x3e0293ee
    s_mov_b32 s70, 0x41000000
    s_mul_i32 s64, s52, 4608
    s_add_u32 s61, s64, 98304
    s_mul_i32 s63, s54, 589824
    s_add_u32 s63, s63, s64
    s_add_u32 s74, s62, 512
    s_mov_b32 s75, s61
    s_lshl_b32 s77, s61, 1
    s_add_u32 s77, s77, 18432
    v_xor_b32 v3, v18, v17
    v_lshlrev_b32 v3, 4, v3
    v_and_b32 v255, 31, v0
    v_lshl_add_u32 v241, v255, 8, v3
    s_lshl_b32 s64, s65, 13
    v_add_u32 v241, s64, v241
    v_lshrrev_b32 v3, 2, v17
    v_and_b32 v255, 3, v0
    v_lshlrev_b32 v255, 3, v255
    v_lshl_add_u32 v254, v16, 2, v3
    v_bfe_u32 v247, v254, 1, 2
    v_mul_u32_u24 v254, 1152, v254
    v_add_u32 v254, v254, v255
    s_add_u32 s64, s52, 0
    s_and_b32 s64, s64, 3
    s_mul_i32 s66, s52, 9
    s_add_u32 s66, s66, 0
    s_sub_u32 s66, s66, s64
    s_lshl_b32 s66, s66, 5
    s_add_u32 s66, s66, 98304
    v_xor_b32 v1, s64, v247
    v_lshl_add_u32 v1, v1, 5, v254
    v_add_u32 v248, s66, v1
    s_add_u32 s64, s52, 1
    s_and_b32 s64, s64, 3
    s_mul_i32 s66, s52, 9
    s_add_u32 s66, s66, 1
    s_sub_u32 s66, s66, s64
    s_lshl_b32 s66, s66, 5
    s_add_u32 s66, s66, 98304
    v_xor_b32 v1, s64, v247
    v_lshl_add_u32 v1, v1, 5, v254
    v_add_u32 v249, s66, v1
    s_add_u32 s64, s52, 2
    s_and_b32 s64, s64, 3
    s_mul_i32 s66, s52, 9
    s_add_u32 s66, s66, 2
    s_sub_u32 s66, s66, s64
    s_lshl_b32 s66, s66, 5
    s_add_u32 s66, s66, 98304
    v_xor_b32 v1, s64, v247
    v_lshl_add_u32 v1, v1, 5, v254
    v_add_u32 v250, s66, v1
    s_add_u32 s64, s52, 3
    s_and_b32 s64, s64, 3
    s_mul_i32 s66, s52, 9
    s_add_u32 s66, s66, 3
    s_sub_u32 s66, s66, s64
    s_lshl_b32 s66, s66, 5
    s_add_u32 s66, s66, 98304
    v_xor_b32 v1, s64, v247
    v_lshl_add_u32 v1, v1, 5, v254
    v_add_u32 v251, s66, v1
    v_and_b32 v254, 1, v16
    v_lshl_add_u32 v255, v254, 5, v255
    v_lshl_add_u32 v247, v18, 3, v3
    v_lshl_add_u32 v243, v247, 7, v255
    v_lshrrev_b32 v247, 1, v3
    v_lshl_add_u32 v243, v247, 6, v243
    v_lshl_add_u32 v247, v18, 2, v3
    v_lshl_add_u32 v242, v247, 8, v255
    v_lshl_add_u32 v242, v3, 6, v242
    s_lshl_b32 s64, s65, 7
    v_xor_b32 v242, s64, v242
    s_lshl_b32 s64, s65, 13
    s_add_u32 s64, s64, 16384
    v_add_u32 v242, s64, v242
    v_and_b32 v3, 1, v16
    v_xor_b32 v3, v3, v18
    v_and_b32 v255, 7, v0
    v_lshl_add_u32 v3, v255, 1, v3
    v_lshlrev_b32 v3, 4, v3
    v_bfe_u32 v255, v0, 3, 2
    v_mul_u32_u24 v255, 9216, v255
    s_mov_b32 s64, 98304
    v_add3_u32 v4, v3, v255, s64
    s_bitcmp1_b32 s53, 0
    s_cbranch_scc1 L_ALT1B
    s_add_u32 m0, s71, 0
    s_add_u32 s64, s62, 0
    buffer_load_dwordx4 v237, s[28:31], s64 offen offset:0 lds
    s_add_u32 s64, s62, 64512
    buffer_load_dwordx4 v237, s[28:31], s64 offen offset:1024 lds
    s_add_u32 s64, s62, 129024
    buffer_load_dwordx4 v237, s[28:31], s64 offen offset:2048 lds
    s_add_u32 s64, s62, 193536
    buffer_load_dwordx4 v237, s[28:31], s64 offen offset:3072 lds
    s_add_u32 m0, s71, 16384
    s_add_u32 s64, s62, 262144
    buffer_load_dwordx4 v237, s[28:31], s64 offen offset:0 lds
    s_add_u32 s64, s62, 326656
    buffer_load_dwordx4 v237, s[28:31], s64 offen offset:1024 lds
    s_add_u32 s64, s62, 391168
    buffer_load_dwordx4 v237, s[28:31], s64 offen offset:2048 lds
    s_add_u32 s64, s62, 455680
    buffer_load_dwordx4 v237, s[28:31], s64 offen offset:3072 lds
    s_waitcnt vmcnt(9)
    s_barrier
    ds_read_b128 a[0:3], v4 offset:0
    ds_read_b128 a[4:7], v4 offset:256
    ds_read_b128 a[8:11], v4 offset:512
    ds_read_b128 a[12:15], v4 offset:768
    s_add_u32 m0, s71, 32768
    s_add_u32 s64, s62, 524288
    buffer_load_dwordx4 v237, s[28:31], s64 offen offset:0 lds
    s_add_u32 s64, s62, 588800
    buffer_load_dwordx4 v237, s[28:31], s64 offen offset:1024 lds
    s_add_u32 s64, s62, 653312
    buffer_load_dwordx4 v237, s[28:31], s64 offen offset:2048 lds
    s_add_u32 s64, s62, 717824
    buffer_load_dwordx4 v237, s[28:31], s64 offen offset:3072 lds
    s_add_u32 m0, s71, 49152
    s_add_u32 s64, s62, 786432
    buffer_load_dwordx4 v237, s[28:31], s64 offen offset:0 lds
    s_add_u32 s64, s62, 850944
    buffer_load_dwordx4 v237, s[28:31], s64 offen offset:1024 lds
    s_add_u32 s64, s62, 915456
    buffer_load_dwordx4 v237, s[28:31], s64 offen offset:2048 lds
    s_add_u32 s64, s62, 979968
    buffer_load_dwordx4 v237, s[28:31], s64 offen offset:3072 lds
    s_add_u32 m0, s71, 65536
    s_add_u32 s64, s62, 1048576
    buffer_load_dwordx4 v237, s[28:31], s64 offen offset:0 lds
    s_add_u32 s64, s62, 1113088
    buffer_load_dwordx4 v237, s[28:31], s64 offen offset:1024 lds
    s_add_u32 s64, s62, 1177600
    buffer_load_dwordx4 v237, s[28:31], s64 offen offset:2048 lds
    s_add_u32 s64, s62, 1242112
    buffer_load_dwordx4 v237, s[28:31], s64 offen offset:3072 lds
    s_add_u32 m0, s71, 81920
    s_add_u32 s64, s62, 1310720
    buffer_load_dwordx4 v237, s[28:31], s64 offen offset:0 lds
    s_add_u32 s64, s62, 1375232
    buffer_load_dwordx4 v237, s[28:31], s64 offen offset:1024 lds
    s_add_u32 s64, s62, 1439744
    buffer_load_dwordx4 v237, s[28:31], s64 offen offset:2048 lds
    s_add_u32 s64, s62, 1504256
    buffer_load_dwordx4 v237, s[28:31], s64 offen offset:3072 lds
    s_waitcnt vmcnt(16)
    s_add_u32 s64, s71, 0
    v_add_u32 v1, s64, v243
    v_xor_b32 v2, 64, v1
    ds_read_b64_tr_b16 v[32:33], v1 offset:0
    ds_read_b64_tr_b16 v[34:35], v1 offset:512
    ds_read_b64_tr_b16 v[36:37], v2 offset:0
    ds_read_b64_tr_b16 v[38:39], v2 offset:512
    ds_read_b64_tr_b16 v[40:41], v1 offset:2048
    ds_read_b64_tr_b16 v[42:43], v1 offset:2560
    ds_read_b64_tr_b16 v[44:45], v2 offset:2048
    ds_read_b64_tr_b16 v[46:47], v2 offset:2560
    ds_read_b64_tr_b16 v[48:49], v1 offset:16384
    ds_read_b64_tr_b16 v[50:51], v1 offset:16896
    ds_read_b64_tr_b16 v[52:53], v2 offset:16384
    ds_read_b64_tr_b16 v[54:55], v2 offset:16896
    s_waitcnt lgkmcnt(8)
    v_mfma_f32_32x32x16_bf16 v[128:143], v[32:35], a[0:3], 0
    v_mfma_f32_32x32x16_bf16 v[144:159], v[36:39], a[0:3], 0
    ds_read_b64_tr_b16 v[56:57], v1 offset:18432
    ds_read_b64_tr_b16 v[58:59], v1 offset:18944
    ds_read_b64_tr_b16 v[60:61], v2 offset:18432
    ds_read_b64_tr_b16 v[62:63], v2 offset:18944
    s_waitcnt lgkmcnt(8)
    v_mfma_f32_32x32x16_bf16 v[128:143], v[40:43], a[4:7], v[128:143]
    v_mfma_f32_32x32x16_bf16 v[144:159], v[44:47], a[4:7], v[144:159]
    s_waitcnt lgkmcnt(0)
    v_mfma_f32_32x32x16_bf16 v[128:143], v[48:51], a[8:11], v[128:143]
    v_mfma_f32_32x32x16_bf16 v[144:159], v[52:55], a[8:11], v[144:159]
    v_mfma_f32_32x32x16_bf16 v[128:143], v[56:59], a[12:15], v[128:143]
    v_mfma_f32_32x32x16_bf16 v[144:159], v[60:63], a[12:15], v[144:159]
    ds_read_b128 a[16:19], v4 offset:1024
    ds_read_b128 a[20:23], v4 offset:1280
    ds_read_b128 a[24:27], v4 offset:1536
    ds_read_b128 a[28:31], v4 offset:1792
    s_add_u32 m0, s71, 0
    s_add_u32 s64, s62, 1572864
    buffer_load_dwordx4 v237, s[28:31], s64 offen offset:0 lds
    s_add_u32 s64, s62, 1637376
    buffer_load_dwordx4 v237, s[28:31], s64 offen offset:1024 lds
    s_add_u32 s64, s62, 1701888
    buffer_load_dwordx4 v237, s[28:31], s64 offen offset:2048 lds
    s_add_u32 s64, s62, 1766400
    buffer_load_dwordx4 v237, s[28:31], s64 offen offset:3072 lds
    s_add_u32 m0, s71, 16384
    s_add_u32 s64, s62, 1835008
    buffer_load_dwordx4 v237, s[28:31], s64 offen offset:0 lds
    s_add_u32 s64, s62, 1899520
    buffer_load_dwordx4 v237, s[28:31], s64 offen offset:1024 lds
    s_add_u32 s64, s62, 1964032
    buffer_load_dwordx4 v237, s[28:31], s64 offen offset:2048 lds
    s_add_u32 s64, s62, 2028544
    buffer_load_dwordx4 v237, s[28:31], s64 offen offset:3072 lds
    s_waitcnt vmcnt(16)
    s_add_u32 s64, s71, 32768
    v_add_u32 v1, s64, v243
    v_xor_b32 v2, 64, v1
    ds_read_b64_tr_b16 v[32:33], v1 offset:0
    ds_read_b64_tr_b16 v[34:35], v1 offset:512
    ds_read_b64_tr_b16 v[36:37], v2 offset:0
    ds_read_b64_tr_b16 v[38:39], v2 offset:512
    ds_read_b64_tr_b16 v[40:41], v1 offset:2048
    ds_read_b64_tr_b16 v[42:43], v1 offset:2560
    ds_read_b64_tr_b16 v[44:45], v2 offset:2048
    ds_read_b64_tr_b16 v[46:47], v2 offset:2560
    ds_read_b64_tr_b16 v[48:49], v1 offset:16384
    ds_read_b64_tr_b16 v[50:51], v1 offset:16896
    ds_read_b64_tr_b16 v[52:53], v2 offset:16384
    ds_read_b64_tr_b16 v[54:55], v2 offset:16896
    s_waitcnt lgkmcnt(8)
    v_mfma_f32_32x32x16_bf16 v[128:143], v[32:35], a[16:19], v[128:143]
    v_mfma_f32_32x32x16_bf16 v[144:159], v[36:39], a[16:19], v[144:159]
    ds_read_b64_tr_b16 v[56:57], v1 offset:18432
    ds_read_b64_tr_b16 v[58:59], v1 offset:18944
    ds_read_b64_tr_b16 v[60:61], v2 offset:18432
    ds_read_b64_tr_b16 v[62:63], v2 offset:18944
    s_waitcnt lgkmcnt(8)
    v_mfma_f32_32x32x16_bf16 v[128:143], v[40:43], a[20:23], v[128:143]
    v_mfma_f32_32x32x16_bf16 v[144:159], v[44:47], a[20:23], v[144:159]
    s_waitcnt lgkmcnt(0)
    v_mfma_f32_32x32x16_bf16 v[128:143], v[48:51], a[24:27], v[128:143]
    v_mfma_f32_32x32x16_bf16 v[144:159], v[52:55], a[24:27], v[144:159]
    v_mfma_f32_32x32x16_bf16 v[128:143], v[56:59], a[28:31], v[128:143]
    v_mfma_f32_32x32x16_bf16 v[144:159], v[60:63], a[28:31], v[144:159]
    ds_read_b128 a[32:35], v4 offset:2048
    ds_read_b128 a[36:39], v4 offset:2304
    ds_read_b128 a[40:43], v4 offset:2560
    ds_read_b128 a[44:47], v4 offset:2816
    s_add_u32 m0, s71, 32768
    s_add_u32 s64, s62, 2097152
    buffer_load_dwordx4 v237, s[28:31], s64 offen offset:0 lds
    s_add_u32 s64, s62, 2161664
    buffer_load_dwordx4 v237, s[28:31], s64 offen offset:1024 lds
    s_add_u32 s64, s62, 2226176
    buffer_load_dwordx4 v237, s[28:31], s64 offen offset:2048 lds
    s_add_u32 s64, s62, 2290688
    buffer_load_dwordx4 v237, s[28:31], s64 offen offset:3072 lds
    s_add_u32 m0, s71, 49152
    s_add_u32 s64, s62, 2359296
    buffer_load_dwordx4 v237, s[28:31], s64 offen offset:0 lds
    s_add_u32 s64, s62, 2423808
    buffer_load_dwordx4 v237, s[28:31], s64 offen offset:1024 lds
    s_add_u32 s64, s62, 2488320
    buffer_load_dwordx4 v237, s[28:31], s64 offen offset:2048 lds
    s_add_u32 s64, s62, 2552832
    buffer_load_dwordx4 v237, s[28:31], s64 offen offset:3072 lds
    s_waitcnt vmcnt(16)
    s_add_u32 s64, s71, 65536
    v_add_u32 v1, s64, v243
    v_xor_b32 v2, 64, v1
    ds_read_b64_tr_b16 v[32:33], v1 offset:0
    ds_read_b64_tr_b16 v[34:35], v1 offset:512
    ds_read_b64_tr_b16 v[36:37], v2 offset:0
    ds_read_b64_tr_b16 v[38:39], v2 offset:512
    ds_read_b64_tr_b16 v[40:41], v1 offset:2048
    ds_read_b64_tr_b16 v[42:43], v1 offset:2560
    ds_read_b64_tr_b16 v[44:45], v2 offset:2048
    ds_read_b64_tr_b16 v[46:47], v2 offset:2560
    ds_read_b64_tr_b16 v[48:49], v1 offset:16384
    ds_read_b64_tr_b16 v[50:51], v1 offset:16896
    ds_read_b64_tr_b16 v[52:53], v2 offset:16384
    ds_read_b64_tr_b16 v[54:55], v2 offset:16896
    s_waitcnt lgkmcnt(8)
    v_mfma_f32_32x32x16_bf16 v[128:143], v[32:35], a[32:35], v[128:143]
    v_mfma_f32_32x32x16_bf16 v[144:159], v[36:39], a[32:35], v[144:159]
    ds_read_b64_tr_b16 v[56:57], v1 offset:18432
    ds_read_b64_tr_b16 v[58:59], v1 offset:18944
    ds_read_b64_tr_b16 v[60:61], v2 offset:18432
    ds_read_b64_tr_b16 v[62:63], v2 offset:18944
    s_waitcnt lgkmcnt(8)
    v_mfma_f32_32x32x16_bf16 v[128:143], v[40:43], a[36:39], v[128:143]
    v_mfma_f32_32x32x16_bf16 v[144:159], v[44:47], a[36:39], v[144:159]
    s_waitcnt lgkmcnt(0)
    v_mfma_f32_32x32x16_bf16 v[128:143], v[48:51], a[40:43], v[128:143]
    v_mfma_f32_32x32x16_bf16 v[144:159], v[52:55], a[40:43], v[144:159]
    v_mfma_f32_32x32x16_bf16 v[128:143], v[56:59], a[44:47], v[128:143]
    v_mfma_f32_32x32x16_bf16 v[144:159], v[60:63], a[44:47], v[144:159]
    ds_read_b128 a[48:51], v4 offset:3072
    ds_read_b128 a[52:55], v4 offset:3328
    ds_read_b128 a[56:59], v4 offset:3584
    ds_read_b128 a[60:63], v4 offset:3840
    s_add_u32 m0, s71, 65536
    s_add_u32 s64, s62, 2621440
    buffer_load_dwordx4 v237, s[28:31], s64 offen offset:0 lds
    s_add_u32 s64, s62, 2685952
    buffer_load_dwordx4 v237, s[28:31], s64 offen offset:1024 lds
    s_add_u32 s64, s62, 2750464
    buffer_load_dwordx4 v237, s[28:31], s64 offen offset:2048 lds
    s_add_u32 s64, s62, 2814976
    buffer_load_dwordx4 v237, s[28:31], s64 offen offset:3072 lds
    s_add_u32 m0, s71, 81920
    s_add_u32 s64, s62, 2883584
    buffer_load_dwordx4 v237, s[28:31], s64 offen offset:0 lds
    s_add_u32 s64, s62, 2948096
    buffer_load_dwordx4 v237, s[28:31], s64 offen offset:1024 lds
    s_add_u32 s64, s62, 3012608
    buffer_load_dwordx4 v237, s[28:31], s64 offen offset:2048 lds
    s_add_u32 s64, s62, 3077120
    buffer_load_dwordx4 v237, s[28:31], s64 offen offset:3072 lds
    s_waitcnt vmcnt(16)
    s_add_u32 s64, s71, 0
    v_add_u32 v1, s64, v243
    v_xor_b32 v2, 64, v1
    ds_read_b64_tr_b16 v[32:33], v1 offset:0
    ds_read_b64_tr_b16 v[34:35], v1 offset:512
    ds_read_b64_tr_b16 v[36:37], v2 offset:0
    ds_read_b64_tr_b16 v[38:39], v2 offset:512
    ds_read_b64_tr_b16 v[40:41], v1 offset:2048
    ds_read_b64_tr_b16 v[42:43], v1 offset:2560
    ds_read_b64_tr_b16 v[44:45], v2 offset:2048
    ds_read_b64_tr_b16 v[46:47], v2 offset:2560
    ds_read_b64_tr_b16 v[48:49], v1 offset:16384
    ds_read_b64_tr_b16 v[50:51], v1 offset:16896
    ds_read_b64_tr_b16 v[52:53], v2 offset:16384
    ds_read_b64_tr_b16 v[54:55], v2 offset:16896
    s_waitcnt lgkmcnt(8)
    v_mfma_f32_32x32x16_bf16 v[128:143], v[32:35], a[48:51], v[128:143]
    v_mfma_f32_32x32x16_bf16 v[144:159], v[36:39], a[48:51], v[144:159]
    ds_read_b64_tr_b16 v[56:57], v1 offset:18432
    ds_read_b64_tr_b16 v[58:59], v1 offset:18944
    ds_read_b64_tr_b16 v[60:61], v2 offset:18432
    ds_read_b64_tr_b16 v[62:63], v2 offset:18944
    s_waitcnt lgkmcnt(8)
    v_mfma_f32_32x32x16_bf16 v[128:143], v[40:43], a[52:55], v[128:143]
    v_mfma_f32_32x32x16_bf16 v[144:159], v[44:47], a[52:55], v[144:159]
    s_waitcnt lgkmcnt(0)
    v_mfma_f32_32x32x16_bf16 v[128:143], v[48:51], a[56:59], v[128:143]
    v_mfma_f32_32x32x16_bf16 v[144:159], v[52:55], a[56:59], v[144:159]
    v_mfma_f32_32x32x16_bf16 v[128:143], v[56:59], a[60:63], v[128:143]
    v_mfma_f32_32x32x16_bf16 v[144:159], v[60:63], a[60:63], v[144:159]
    ds_read_b128 a[64:67], v4 offset:4096
    ds_read_b128 a[68:71], v4 offset:4352
    ds_read_b128 a[72:75], v4 offset:4608
    ds_read_b128 a[76:79], v4 offset:4864
    s_add_u32 m0, s71, 0
    s_add_u32 s64, s62, 3145728
    buffer_load_dwordx4 v237, s[28:31], s64 offen offset:0 lds
    s_add_u32 s64, s62, 3210240
    buffer_load_dwordx4 v237, s[28:31], s64 offen offset:1024 lds
    s_add_u32 s64, s62, 3274752
    buffer_load_dwordx4 v237, s[28:31], s64 offen offset:2048 lds
    s_add_u32 s64, s62, 3339264
    buffer_load_dwordx4 v237, s[28:31], s64 offen offset:3072 lds
    s_add_u32 m0, s71, 16384
    s_add_u32 s64, s62, 3407872
    buffer_load_dwordx4 v237, s[28:31], s64 offen offset:0 lds
    s_add_u32 s64, s62, 3472384
    buffer_load_dwordx4 v237, s[28:31], s64 offen offset:1024 lds
    s_add_u32 s64, s62, 3536896
    buffer_load_dwordx4 v237, s[28:31], s64 offen offset:2048 lds
    s_add_u32 s64, s62, 3601408
    buffer_load_dwordx4 v237, s[28:31], s64 offen offset:3072 lds
    s_waitcnt vmcnt(16)
    s_add_u32 s64, s71, 32768
    v_add_u32 v1, s64, v243
    v_xor_b32 v2, 64, v1
    ds_read_b64_tr_b16 v[32:33], v1 offset:0
    ds_read_b64_tr_b16 v[34:35], v1 offset:512
    ds_read_b64_tr_b16 v[36:37], v2 offset:0
    ds_read_b64_tr_b16 v[38:39], v2 offset:512
    ds_read_b64_tr_b16 v[40:41], v1 offset:2048
    ds_read_b64_tr_b16 v[42:43], v1 offset:2560
    ds_read_b64_tr_b16 v[44:45], v2 offset:2048
    ds_read_b64_tr_b16 v[46:47], v2 offset:2560
    ds_read_b64_tr_b16 v[48:49], v1 offset:16384
    ds_read_b64_tr_b16 v[50:51], v1 offset:16896
    ds_read_b64_tr_b16 v[52:53], v2 offset:16384
    ds_read_b64_tr_b16 v[54:55], v2 offset:16896
    s_waitcnt lgkmcnt(8)
    v_mfma_f32_32x32x16_bf16 v[128:143], v[32:35], a[64:67], v[128:143]
    v_mfma_f32_32x32x16_bf16 v[144:159], v[36:39], a[64:67], v[144:159]
    ds_read_b64_tr_b16 v[56:57], v1 offset:18432
    ds_read_b64_tr_b16 v[58:59], v1 offset:18944
    ds_read_b64_tr_b16 v[60:61], v2 offset:18432
    ds_read_b64_tr_b16 v[62:63], v2 offset:18944
    s_waitcnt lgkmcnt(8)
    v_mfma_f32_32x32x16_bf16 v[128:143], v[40:43], a[68:71], v[128:143]
    v_mfma_f32_32x32x16_bf16 v[144:159], v[44:47], a[68:71], v[144:159]
    s_waitcnt lgkmcnt(0)
    v_mfma_f32_32x32x16_bf16 v[128:143], v[48:51], a[72:75], v[128:143]
    v_mfma_f32_32x32x16_bf16 v[144:159], v[52:55], a[72:75], v[144:159]
    v_mfma_f32_32x32x16_bf16 v[128:143], v[56:59], a[76:79], v[128:143]
    v_mfma_f32_32x32x16_bf16 v[144:159], v[60:63], a[76:79], v[144:159]
    ds_read_b128 a[80:83], v4 offset:5120
    ds_read_b128 a[84:87], v4 offset:5376
    ds_read_b128 a[88:91], v4 offset:5632
    ds_read_b128 a[92:95], v4 offset:5888
    s_add_u32 m0, s71, 32768
    s_add_u32 s64, s62, 3670016
    buffer_load_dwordx4 v237, s[28:31], s64 offen offset:0 lds
    s_add_u32 s64, s62, 3734528
    buffer_load_dwordx4 v237, s[28:31], s64 offen offset:1024 lds
    s_add_u32 s64, s62, 3799040
    buffer_load_dwordx4 v237, s[28:31], s64 offen offset:2048 lds
    s_add_u32 s64, s62, 3863552
    buffer_load_dwordx4 v237, s[28:31], s64 offen offset:3072 lds
    s_add_u32 m0, s71, 49152
    s_add_u32 s64, s62, 3932160
    buffer_load_dwordx4 v237, s[28:31], s64 offen offset:0 lds
    s_add_u32 s64, s62, 3996672
    buffer_load_dwordx4 v237, s[28:31], s64 offen offset:1024 lds
    s_add_u32 s64, s62, 4061184
    buffer_load_dwordx4 v237, s[28:31], s64 offen offset:2048 lds
    s_add_u32 s64, s62, 4125696
    buffer_load_dwordx4 v237, s[28:31], s64 offen offset:3072 lds
    s_waitcnt vmcnt(16)
    s_add_u32 s64, s71, 65536
    v_add_u32 v1, s64, v243
    v_xor_b32 v2, 64, v1
    ds_read_b64_tr_b16 v[32:33], v1 offset:0
    ds_read_b64_tr_b16 v[34:35], v1 offset:512
    ds_read_b64_tr_b16 v[36:37], v2 offset:0
    ds_read_b64_tr_b16 v[38:39], v2 offset:512
    ds_read_b64_tr_b16 v[40:41], v1 offset:2048
    ds_read_b64_tr_b16 v[42:43], v1 offset:2560
    ds_read_b64_tr_b16 v[44:45], v2 offset:2048
    ds_read_b64_tr_b16 v[46:47], v2 offset:2560
    ds_read_b64_tr_b16 v[48:49], v1 offset:16384
    ds_read_b64_tr_b16 v[50:51], v1 offset:16896
    ds_read_b64_tr_b16 v[52:53], v2 offset:16384
    ds_read_b64_tr_b16 v[54:55], v2 offset:16896
    s_waitcnt lgkmcnt(8)
    v_mfma_f32_32x32x16_bf16 v[128:143], v[32:35], a[80:83], v[128:143]
    v_mfma_f32_32x32x16_bf16 v[144:159], v[36:39], a[80:83], v[144:159]
    ds_read_b64_tr_b16 v[56:57], v1 offset:18432
    ds_read_b64_tr_b16 v[58:59], v1 offset:18944
    ds_read_b64_tr_b16 v[60:61], v2 offset:18432
    ds_read_b64_tr_b16 v[62:63], v2 offset:18944
    s_waitcnt lgkmcnt(8)
    v_mfma_f32_32x32x16_bf16 v[128:143], v[40:43], a[84:87], v[128:143]
    v_mfma_f32_32x32x16_bf16 v[144:159], v[44:47], a[84:87], v[144:159]
    s_waitcnt lgkmcnt(0)
    v_mfma_f32_32x32x16_bf16 v[128:143], v[48:51], a[88:91], v[128:143]
    v_mfma_f32_32x32x16_bf16 v[144:159], v[52:55], a[88:91], v[144:159]
    v_mfma_f32_32x32x16_bf16 v[128:143], v[56:59], a[92:95], v[128:143]
    v_mfma_f32_32x32x16_bf16 v[144:159], v[60:63], a[92:95], v[144:159]
    ds_read_b128 a[96:99], v4 offset:6144
    ds_read_b128 a[100:103], v4 offset:6400
    ds_read_b128 a[104:107], v4 offset:6656
    ds_read_b128 a[108:111], v4 offset:6912
    s_add_u32 m0, s71, 65536
    s_add_u32 s64, s62, 4194304
    buffer_load_dwordx4 v237, s[28:31], s64 offen offset:0 lds
    s_add_u32 s64, s62, 4258816
    buffer_load_dwordx4 v237, s[28:31], s64 offen offset:1024 lds
    s_add_u32 s64, s62, 4323328
    buffer_load_dwordx4 v237, s[28:31], s64 offen offset:2048 lds
    s_add_u32 s64, s62, 4387840
    buffer_load_dwordx4 v237, s[28:31], s64 offen offset:3072 lds
    s_add_u32 m0, s71, 81920
    s_add_u32 s64, s62, 4456448
    buffer_load_dwordx4 v237, s[28:31], s64 offen offset:0 lds
    s_add_u32 s64, s62, 4520960
    buffer_load_dwordx4 v237, s[28:31], s64 offen offset:1024 lds
    s_add_u32 s64, s62, 4585472
    buffer_load_dwordx4 v237, s[28:31], s64 offen offset:2048 lds
    s_add_u32 s64, s62, 4649984
    buffer_load_dwordx4 v237, s[28:31], s64 offen offset:3072 lds
    v_mov_b64 v[64:65], 0
    v_mov_b64 v[66:67], 0
    v_mov_b64 v[68:69], 0
    v_mov_b64 v[70:71], 0
    v_mov_b64 v[72:73], 0
    v_mov_b64 v[74:75], 0
    v_mov_b64 v[76:77], 0
    v_mov_b64 v[78:79], 0
    v_mov_b64 v[80:81], 0
    v_mov_b64 v[82:83], 0
    v_mov_b64 v[84:85], 0
    v_mov_b64 v[86:87], 0
    v_mov_b64 v[88:89], 0
    v_mov_b64 v[90:91], 0
    v_mov_b64 v[92:93], 0
    v_mov_b64 v[94:95], 0
    v_mov_b64 v[96:97], 0
    v_mov_b64 v[98:99], 0
    v_mov_b64 v[100:101], 0
    v_mov_b64 v[102:103], 0
    v_mov_b64 v[104:105], 0
    v_mov_b64 v[106:107], 0
    v_mov_b64 v[108:109], 0
    v_mov_b64 v[110:111], 0
    v_mov_b64 v[112:113], 0
    v_mov_b64 v[114:115], 0
    v_mov_b64 v[116:117], 0
    v_mov_b64 v[118:119], 0
    v_mov_b64 v[120:121], 0
    v_mov_b64 v[122:123], 0
    v_mov_b64 v[124:125], 0
    v_mov_b64 v[126:127], 0
    v_mov_b32 v252, 0xfe000000
    v_mov_b32 v253, 0
    s_waitcnt vmcnt(16)
    s_add_u32 s64, s71, 0
    v_add_u32 v1, s64, v243
    v_xor_b32 v2, 64, v1
    ds_read_b64_tr_b16 v[32:33], v1 offset:0
    ds_read_b64_tr_b16 v[34:35], v1 offset:512
    ds_read_b64_tr_b16 v[36:37], v2 offset:0
    ds_read_b64_tr_b16 v[38:39], v2 offset:512
    ds_read_b64_tr_b16 v[40:41], v1 offset:2048
    ds_read_b64_tr_b16 v[42:43], v1 offset:2560
    ds_read_b64_tr_b16 v[44:45], v2 offset:2048
    ds_read_b64_tr_b16 v[46:47], v2 offset:2560
    ds_read_b64_tr_b16 v[48:49], v1 offset:16384
    ds_read_b64_tr_b16 v[50:51], v1 offset:16896
    ds_read_b64_tr_b16 v[52:53], v2 offset:16384
    ds_read_b64_tr_b16 v[54:55], v2 offset:16896
    s_waitcnt lgkmcnt(8)
    v_mfma_f32_32x32x16_bf16 v[128:143], v[32:35], a[96:99], v[128:143]
    v_mfma_f32_32x32x16_bf16 v[144:159], v[36:39], a[96:99], v[144:159]
    ds_read_b64_tr_b16 v[56:57], v1 offset:18432
    ds_read_b64_tr_b16 v[58:59], v1 offset:18944
    ds_read_b64_tr_b16 v[60:61], v2 offset:18432
    ds_read_b64_tr_b16 v[62:63], v2 offset:18944
    s_waitcnt lgkmcnt(8)
    v_mfma_f32_32x32x16_bf16 v[128:143], v[40:43], a[100:103], v[128:143]
    v_mfma_f32_32x32x16_bf16 v[144:159], v[44:47], a[100:103], v[144:159]
    s_waitcnt lgkmcnt(0)
    v_mfma_f32_32x32x16_bf16 v[128:143], v[48:51], a[104:107], v[128:143]
    v_mfma_f32_32x32x16_bf16 v[144:159], v[52:55], a[104:107], v[144:159]
    v_mfma_f32_32x32x16_bf16 v[128:143], v[56:59], a[108:111], v[128:143]
    v_mfma_f32_32x32x16_bf16 v[144:159], v[60:63], a[108:111], v[144:159]
    ds_read_b128 a[112:115], v4 offset:7168
    ds_read_b128 a[116:119], v4 offset:7424
    ds_read_b128 a[120:123], v4 offset:7680
    ds_read_b128 a[124:127], v4 offset:7936
    s_mov_b32 m0, s56
    s_nop 0
    buffer_load_dwordx4 v232, s[20:23], s55 offen offset:0 nt lds
    buffer_load_dwordx4 v233, s[20:23], s55 offen offset:1024 nt lds
    buffer_load_dwordx4 v234, s[20:23], s55 offen offset:2048 nt lds
    buffer_load_dwordx4 v235, s[20:23], s55 offen offset:3072 nt lds
    s_mov_b32 s78, s55
    s_add_u32 s79, s56, 16384
    s_add_u32 s55, s55, 16384
    s_add_u32 s56, s56, 32768
    s_cmp_ge_u32 s56, 98304
    s_cselect_b32 s64, 98304, 0
    s_sub_u32 s56, s56, s64
    s_mov_b32 m0, s79
    s_nop 0
    buffer_load_dwordx4 v236, s[24:27], s78 offen offset:0 nt lds
    buffer_load_dwordx4 v236, s[24:27], s78 offen offset:1024 nt lds
    buffer_load_dwordx4 v236, s[24:27], s78 offen offset:2048 nt lds
    buffer_load_dwordx4 v236, s[24:27], s78 offen offset:3072 nt lds
    s_waitcnt vmcnt(16)
    s_add_u32 s64, s71, 32768
    v_add_u32 v1, s64, v243
    v_xor_b32 v2, 64, v1
    ds_read_b64_tr_b16 v[32:33], v1 offset:0
    ds_read_b64_tr_b16 v[34:35], v1 offset:512
    ds_read_b64_tr_b16 v[36:37], v2 offset:0
    ds_read_b64_tr_b16 v[38:39], v2 offset:512
    ds_read_b64_tr_b16 v[40:41], v1 offset:2048
    ds_read_b64_tr_b16 v[42:43], v1 offset:2560
    ds_read_b64_tr_b16 v[44:45], v2 offset:2048
    ds_read_b64_tr_b16 v[46:47], v2 offset:2560
    ds_read_b64_tr_b16 v[48:49], v1 offset:16384
    ds_read_b64_tr_b16 v[50:51], v1 offset:16896
    ds_read_b64_tr_b16 v[52:53], v2 offset:16384
    ds_read_b64_tr_b16 v[54:55], v2 offset:16896
    s_waitcnt lgkmcnt(8)
    v_mfma_f32_32x32x16_bf16 v[128:143], v[32:35], a[112:115], v[128:143]
    v_mfma_f32_32x32x16_bf16 v[144:159], v[36:39], a[112:115], v[144:159]
    ds_read_b64_tr_b16 v[56:57], v1 offset:18432
    ds_read_b64_tr_b16 v[58:59], v1 offset:18944
    ds_read_b64_tr_b16 v[60:61], v2 offset:18432
    ds_read_b64_tr_b16 v[62:63], v2 offset:18944
    s_waitcnt lgkmcnt(8)
    v_mfma_f32_32x32x16_bf16 v[128:143], v[40:43], a[116:119], v[128:143]
    v_mfma_f32_32x32x16_bf16 v[144:159], v[44:47], a[116:119], v[144:159]
    s_waitcnt lgkmcnt(0)
    v_mfma_f32_32x32x16_bf16 v[128:143], v[48:51], a[120:123], v[128:143]
    v_mfma_f32_32x32x16_bf16 v[144:159], v[52:55], a[120:123], v[144:159]
    v_mfma_f32_32x32x16_bf16 v[128:143], v[56:59], a[124:127], v[128:143]
    v_mfma_f32_32x32x16_bf16 v[144:159], v[60:63], a[124:127], v[144:159]
    ds_read_b128 a[128:131], v4 offset:8192
    ds_read_b128 a[132:135], v4 offset:8448
    ds_read_b128 a[136:139], v4 offset:8704
    ds_read_b128 a[140:143], v4 offset:8960
    s_waitcnt vmcnt(8)
    s_add_u32 s64, s71, 65536
    v_add_u32 v1, s64, v243
    v_xor_b32 v2, 64, v1
    ds_read_b64_tr_b16 v[32:33], v1 offset:0
    ds_read_b64_tr_b16 v[34:35], v1 offset:512
    ds_read_b64_tr_b16 v[36:37], v2 offset:0
    ds_read_b64_tr_b16 v[38:39], v2 offset:512
    ds_read_b64_tr_b16 v[40:41], v1 offset:2048
    ds_read_b64_tr_b16 v[42:43], v1 offset:2560
    ds_read_b64_tr_b16 v[44:45], v2 offset:2048
    ds_read_b64_tr_b16 v[46:47], v2 offset:2560
    ds_read_b64_tr_b16 v[48:49], v1 offset:16384
    ds_read_b64_tr_b16 v[50:51], v1 offset:16896
    ds_read_b64_tr_b16 v[52:53], v2 offset:16384
    ds_read_b64_tr_b16 v[54:55], v2 offset:16896
    s_waitcnt lgkmcnt(8)
    v_mfma_f32_32x32x16_bf16 v[128:143], v[32:35], a[128:131], v[128:143]
    v_mfma_f32_32x32x16_bf16 v[144:159], v[36:39], a[128:131], v[144:159]
    ds_read_b64_tr_b16 v[56:57], v1 offset:18432
    ds_read_b64_tr_b16 v[58:59], v1 offset:18944
    ds_read_b64_tr_b16 v[60:61], v2 offset:18432
    ds_read_b64_tr_b16 v[62:63], v2 offset:18944
    s_waitcnt lgkmcnt(8)
    v_mfma_f32_32x32x16_bf16 v[128:143], v[40:43], a[132:135], v[128:143]
    v_mfma_f32_32x32x16_bf16 v[144:159], v[44:47], a[132:135], v[144:159]
    s_waitcnt lgkmcnt(0)
    v_mfma_f32_32x32x16_bf16 v[128:143], v[48:51], a[136:139], v[128:143]
    v_mfma_f32_32x32x16_bf16 v[144:159], v[52:55], a[136:139], v[144:159]
    v_mfma_f32_32x32x16_bf16 v[128:143], v[56:59], a[140:143], v[128:143]
    v_mfma_f32_32x32x16_bf16 v[144:159], v[60:63], a[140:143], v[144:159]
    s_add_u32 s66, s71, 135168
    v_and_b32 v1, 31, v0
    v_lshlrev_b32 v1, 4, v1
    v_lshrrev_b32 v3, 5, v0
    v_lshl_add_u32 v1, v3, 3, v1
    v_add_u32 v1, s66, v1
    s_nop 5
    v_cvt_pk_bf16_f32 v128, v128, v129
    v_cvt_pk_bf16_f32 v129, v130, v131
    ds_write_b64 v1, v[128:129] offset:0
    v_cvt_pk_bf16_f32 v132, v132, v133
    v_cvt_pk_bf16_f32 v133, v134, v135
    ds_write_b64 v1, v[132:133] offset:512
    v_cvt_pk_bf16_f32 v136, v136, v137
    v_cvt_pk_bf16_f32 v137, v138, v139
    ds_write_b64 v1, v[136:137] offset:1024
    v_cvt_pk_bf16_f32 v140, v140, v141
    v_cvt_pk_bf16_f32 v141, v142, v143
    ds_write_b64 v1, v[140:141] offset:1536
    v_cvt_pk_bf16_f32 v144, v144, v145
    v_cvt_pk_bf16_f32 v145, v146, v147
    ds_write_b64 v1, v[144:145] offset:2048
    v_cvt_pk_bf16_f32 v148, v148, v149
    v_cvt_pk_bf16_f32 v149, v150, v151
    ds_write_b64 v1, v[148:149] offset:2560
    v_cvt_pk_bf16_f32 v152, v152, v153
    v_cvt_pk_bf16_f32 v153, v154, v155
    ds_write_b64 v1, v[152:153] offset:3072
    v_cvt_pk_bf16_f32 v156, v156, v157
    v_cvt_pk_bf16_f32 v157, v158, v159
    ds_write_b64 v1, v[156:157] offset:3584
    s_waitcnt lgkmcnt(0)
    s_barrier
    s_and_b32 s64, s52, 1
    s_lshl_b32 s64, s64, 13
    s_add_u32 s64, s64, 135168
    v_lshl_add_u32 v1, v0, 4, s64
    ds_read_b128 v[200:203], v1 offset:0
    ds_read_b128 v[204:207], v1 offset:1024
    ds_read_b128 v[208:211], v1 offset:2048
    ds_read_b128 v[212:215], v1 offset:3072
    ds_read_b128 v[216:219], v1 offset:4096
    ds_read_b128 v[220:223], v1 offset:5120
    ds_read_b128 v[224:227], v1 offset:6144
    ds_read_b128 v[228:231], v1 offset:7168
    s_mov_b32 m0, s56
    s_nop 0
    buffer_load_dwordx4 v232, s[20:23], s55 offen offset:0 nt lds
    buffer_load_dwordx4 v233, s[20:23], s55 offen offset:1024 nt lds
    buffer_load_dwordx4 v234, s[20:23], s55 offen offset:2048 nt lds
    buffer_load_dwordx4 v235, s[20:23], s55 offen offset:3072 nt lds
    s_mov_b32 s78, s55
    s_add_u32 s79, s56, 16384
    s_add_u32 s55, s55, 16384
    s_add_u32 s56, s56, 32768
    s_cmp_ge_u32 s56, 98304
    s_cselect_b32 s64, 98304, 0
    s_sub_u32 s56, s56, s64
    s_mov_b32 m0, s79
    s_nop 0
    buffer_load_dwordx4 v236, s[24:27], s78 offen offset:0 nt lds
    buffer_load_dwordx4 v236, s[24:27], s78 offen offset:1024 nt lds
    buffer_load_dwordx4 v236, s[24:27], s78 offen offset:2048 nt lds
    buffer_load_dwordx4 v236, s[24:27], s78 offen offset:3072 nt lds
    s_mov_b32 m0, s56
    s_nop 0
    buffer_load_dwordx4 v232, s[20:23], s55 offen offset:0 nt lds
    buffer_load_dwordx4 v233, s[20:23], s55 offen offset:1024 nt lds
    buffer_load_dwordx4 v234, s[20:23], s55 offen offset:2048 nt lds
    buffer_load_dwordx4 v235, s[20:23], s55 offen offset:3072 nt lds
    s_mov_b32 s78, s55
    s_add_u32 s79, s56, 16384
    s_add_u32 s55, s55, 16384
    s_add_u32 s56, s56, 32768
    s_cmp_ge_u32 s56, 98304
    s_cselect_b32 s64, 98304, 0
    s_sub_u32 s56, s56, s64
    s_branch L_ALT1E
L_ALT1B:
    s_mov_b32 m0, s56
    s_nop 0
    buffer_load_dwordx4 v232, s[20:23], s55 offen offset:0 nt lds
    buffer_load_dwordx4 v233, s[20:23], s55 offen offset:1024 nt lds
    buffer_load_dwordx4 v234, s[20:23], s55 offen offset:2048 nt lds
    buffer_load_dwordx4 v235, s[20:23], s55 offen offset:3072 nt lds
    s_mov_b32 s78, s55
    s_add_u32 s79, s56, 16384
    s_add_u32 s55, s55, 16384
    s_add_u32 s56, s56, 32768
    s_cmp_ge_u32 s56, 98304
    s_cselect_b32 s64, 98304, 0
    s_sub_u32 s56, s56, s64
    s_mov_b32 m0, s79
    s_nop 0
    buffer_load_dwordx4 v236, s[24:27], s78 offen offset:0 nt lds
    buffer_load_dwordx4 v236, s[24:27], s78 offen offset:1024 nt lds
    buffer_load_dwordx4 v236, s[24:27], s78 offen offset:2048 nt lds
    buffer_load_dwordx4 v236, s[24:27], s78 offen offset:3072 nt lds
    s_waitcnt vmcnt(9)
    s_barrier
    ds_read_b128 a[0:3], v4 offset:0
    ds_read_b128 a[4:7], v4 offset:256
    ds_read_b128 a[8:11], v4 offset:512
    ds_read_b128 a[12:15], v4 offset:768
    ds_read_b128 a[16:19], v4 offset:1024
    ds_read_b128 a[20:23], v4 offset:1280
    ds_read_b128 a[24:27], v4 offset:1536
    ds_read_b128 a[28:31], v4 offset:1792
    ds_read_b128 a[32:35], v4 offset:2048
    s_mov_b32 m0, s56
    s_nop 0
    buffer_load_dwordx4 v232, s[20:23], s55 offen offset:0 nt lds
    buffer_load_dwordx4 v233, s[20:23], s55 offen offset:1024 nt lds
    buffer_load_dwordx4 v234, s[20:23], s55 offen offset:2048 nt lds
    buffer_load_dwordx4 v235, s[20:23], s55 offen offset:3072 nt lds
    s_mov_b32 s78, s55
    s_add_u32 s79, s56, 16384
    s_add_u32 s55, s55, 16384
    s_add_u32 s56, s56, 32768
    s_cmp_ge_u32 s56, 98304
    s_cselect_b32 s64, 98304, 0
    s_sub_u32 s56, s56, s64
    s_waitcnt lgkmcnt(0)
    ds_read_b128 a[36:39], v4 offset:2304
    ds_read_b128 a[40:43], v4 offset:2560
    ds_read_b128 a[44:47], v4 offset:2816
    ds_read_b128 a[48:51], v4 offset:3072
    ds_read_b128 a[52:55], v4 offset:3328
    ds_read_b128 a[56:59], v4 offset:3584
    ds_read_b128 a[60:63], v4 offset:3840
    ds_read_b128 a[64:67], v4 offset:4096
    ds_read_b128 a[68:71], v4 offset:4352
    s_mov_b32 m0, s79
    s_nop 0
    buffer_load_dwordx4 v236, s[24:27], s78 offen offset:0 nt lds
    buffer_load_dwordx4 v236, s[24:27], s78 offen offset:1024 nt lds
    buffer_load_dwordx4 v236, s[24:27], s78 offen offset:2048 nt lds
    buffer_load_dwordx4 v236, s[24:27], s78 offen offset:3072 nt lds
    s_waitcnt lgkmcnt(0)
    ds_read_b128 a[72:75], v4 offset:4608
    ds_read_b128 a[76:79], v4 offset:4864
    ds_read_b128 a[80:83], v4 offset:5120
    ds_read_b128 a[84:87], v4 offset:5376
    ds_read_b128 a[88:91], v4 offset:5632
    ds_read_b128 a[92:95], v4 offset:5888
    ds_read_b128 a[96:99], v4 offset:6144
    ds_read_b128 a[100:103], v4 offset:6400
    ds_read_b128 a[104:107], v4 offset:6656
    s_mov_b32 m0, s56
    s_nop 0
    buffer_load_dwordx4 v232, s[20:23], s55 offen offset:0 nt lds
    buffer_load_dwordx4 v233, s[20:23], s55 offen offset:1024 nt lds
    buffer_load_dwordx4 v234, s[20:23], s55 offen offset:2048 nt lds
    buffer_load_dwordx4 v235, s[20:23], s55 offen offset:3072 nt lds
    s_mov_b32 s78, s55
    s_add_u32 s79, s56, 16384
    s_add_u32 s55, s55, 16384
    s_add_u32 s56, s56, 32768
    s_cmp_ge_u32 s56, 98304
    s_cselect_b32 s64, 98304, 0
    s_sub_u32 s56, s56, s64
    s_waitcnt lgkmcnt(0)
    ds_read_b128 a[108:111], v4 offset:6912
    ds_read_b128 a[112:115], v4 offset:7168
    ds_read_b128 a[116:119], v4 offset:7424
    ds_read_b128 a[120:123], v4 offset:7680
    ds_read_b128 a[124:127], v4 offset:7936
    ds_read_b128 a[128:131], v4 offset:8192
    ds_read_b128 a[132:135], v4 offset:8448
    ds_read_b128 a[136:139], v4 offset:8704
    ds_read_b128 a[140:143], v4 offset:8960
    s_waitcnt lgkmcnt(0)
    s_add_u32 s66, s71, 135168
    s_add_u32 m0, s66, 0
    s_add_u32 s64, s62, 0
    buffer_load_dwordx4 v237, s[28:31], s64 offen offset:0 lds
    s_add_u32 s64, s62, 64512
    buffer_load_dwordx4 v237, s[28:31], s64 offen offset:1024 lds
    s_add_u32 s64, s62, 129024
    buffer_load_dwordx4 v237, s[28:31], s64 offen offset:2048 lds
    s_add_u32 s64, s62, 193536
    buffer_load_dwordx4 v237, s[28:31], s64 offen offset:3072 lds
    s_barrier
    s_add_u32 m0, s96, 0
    s_add_u32 s64, s62, 262144
    buffer_load_dwordx4 v237, s[28:31], s64 offen offset:0 lds
    s_add_u32 s64, s62, 326656
    buffer_load_dwordx4 v237, s[28:31], s64 offen offset:1024 lds
    s_add_u32 s64, s62, 391168
    buffer_load_dwordx4 v237, s[28:31], s64 offen offset:2048 lds
    s_add_u32 s64, s62, 455680
    buffer_load_dwordx4 v237, s[28:31], s64 offen offset:3072 lds
    s_add_u32 m0, s96, 4096
    s_add_u32 s64, s62, 524288
    buffer_load_dwordx4 v237, s[28:31], s64 offen offset:0 lds
    s_add_u32 s64, s62, 588800
    buffer_load_dwordx4 v237, s[28:31], s64 offen offset:1024 lds
    s_add_u32 s64, s62, 653312
    buffer_load_dwordx4 v237, s[28:31], s64 offen offset:2048 lds
    s_add_u32 s64, s62, 717824
    buffer_load_dwordx4 v237, s[28:31], s64 offen offset:3072 lds
    v_mov_b64 v[64:65], 0
    v_mov_b64 v[66:67], 0
    v_mov_b64 v[68:69], 0
    v_mov_b64 v[70:71], 0
    v_mov_b64 v[72:73], 0
    v_mov_b64 v[74:75], 0
    v_mov_b64 v[76:77], 0
    v_mov_b64 v[78:79], 0
    v_mov_b64 v[80:81], 0
    v_mov_b64 v[82:83], 0
    v_mov_b64 v[84:85], 0
    v_mov_b64 v[86:87], 0
    v_mov_b64 v[88:89], 0
    v_mov_b64 v[90:91], 0
    v_mov_b64 v[92:93], 0
    v_mov_b64 v[94:95], 0
    v_mov_b64 v[96:97], 0
    v_mov_b64 v[98:99], 0
    v_mov_b64 v[100:101], 0
    v_mov_b64 v[102:103], 0
    v_mov_b64 v[104:105], 0
    v_mov_b64 v[106:107], 0
    v_mov_b64 v[108:109], 0
    v_mov_b64 v[110:111], 0
    v_mov_b64 v[112:113], 0
    v_mov_b64 v[114:115], 0
    v_mov_b64 v[116:117], 0
    v_mov_b64 v[118:119], 0
    v_mov_b64 v[120:121], 0
    v_mov_b64 v[122:123], 0
    v_mov_b64 v[124:125], 0
    v_mov_b64 v[126:127], 0
    v_mov_b32 v252, 0xfe000000
    v_mov_b32 v253, 0
    s_waitcnt vmcnt(8)
    s_add_u32 s64, s66, 0
    v_add_u32 v1, s64, v243
    v_xor_b32 v2, 64, v1
    ds_read_b64_tr_b16 v[32:33], v1 offset:0
    ds_read_b64_tr_b16 v[34:35], v1 offset:512
    ds_read_b64_tr_b16 v[36:37], v2 offset:0
    ds_read_b64_tr_b16 v[38:39], v2 offset:512
    ds_read_b64_tr_b16 v[40:41], v1 offset:2048
    ds_read_b64_tr_b16 v[42:43], v1 offset:2560
    ds_read_b64_tr_b16 v[44:45], v2 offset:2048
    ds_read_b64_tr_b16 v[46:47], v2 offset:2560
    s_waitcnt lgkmcnt(0)
    v_mfma_f32_32x32x16_bf16 v[128:143], v[32:35], a[0:3], 0
    v_mfma_f32_32x32x16_bf16 v[144:159], v[36:39], a[0:3], 0
    v_mfma_f32_32x32x16_bf16 v[128:143], v[40:43], a[4:7], v[128:143]
    v_mfma_f32_32x32x16_bf16 v[144:159], v[44:47], a[4:7], v[144:159]
    s_add_u32 m0, s66, 0
    s_add_u32 s64, s62, 786432
    buffer_load_dwordx4 v237, s[28:31], s64 offen offset:0 lds
    s_add_u32 s64, s62, 850944
    buffer_load_dwordx4 v237, s[28:31], s64 offen offset:1024 lds
    s_add_u32 s64, s62, 915456
    buffer_load_dwordx4 v237, s[28:31], s64 offen offset:2048 lds
    s_add_u32 s64, s62, 979968
    buffer_load_dwordx4 v237, s[28:31], s64 offen offset:3072 lds
    s_waitcnt vmcnt(8)
    s_add_u32 s64, s96, 0
    v_add_u32 v1, s64, v243
    v_xor_b32 v2, 64, v1
    ds_read_b64_tr_b16 v[48:49], v1 offset:0
    ds_read_b64_tr_b16 v[50:51], v1 offset:512
    ds_read_b64_tr_b16 v[52:53], v2 offset:0
    ds_read_b64_tr_b16 v[54:55], v2 offset:512
    ds_read_b64_tr_b16 v[56:57], v1 offset:2048
    ds_read_b64_tr_b16 v[58:59], v1 offset:2560
    ds_read_b64_tr_b16 v[60:61], v2 offset:2048
    ds_read_b64_tr_b16 v[62:63], v2 offset:2560
    s_waitcnt lgkmcnt(0)
    v_mfma_f32_32x32x16_bf16 v[128:143], v[48:51], a[8:11], v[128:143]
    v_mfma_f32_32x32x16_bf16 v[144:159], v[52:55], a[8:11], v[144:159]
    v_mfma_f32_32x32x16_bf16 v[128:143], v[56:59], a[12:15], v[128:143]
    v_mfma_f32_32x32x16_bf16 v[144:159], v[60:63], a[12:15], v[144:159]
    s_add_u32 m0, s96, 0
    s_add_u32 s64, s62, 1048576
    buffer_load_dwordx4 v237, s[28:31], s64 offen offset:0 lds
    s_add_u32 s64, s62, 1113088
    buffer_load_dwordx4 v237, s[28:31], s64 offen offset:1024 lds
    s_add_u32 s64, s62, 1177600
    buffer_load_dwordx4 v237, s[28:31], s64 offen offset:2048 lds
    s_add_u32 s64, s62, 1242112
    buffer_load_dwordx4 v237, s[28:31], s64 offen offset:3072 lds
    s_waitcnt vmcnt(8)
    s_add_u32 s64, s96, 4096
    v_add_u32 v1, s64, v243
    v_xor_b32 v2, 64, v1
    ds_read_b64_tr_b16 v[32:33], v1 offset:0
    ds_read_b64_tr_b16 v[34:35], v1 offset:512
    ds_read_b64_tr_b16 v[36:37], v2 offset:0
    ds_read_b64_tr_b16 v[38:39], v2 offset:512
    ds_read_b64_tr_b16 v[40:41], v1 offset:2048
    ds_read_b64_tr_b16 v[42:43], v1 offset:2560
    ds_read_b64_tr_b16 v[44:45], v2 offset:2048
    ds_read_b64_tr_b16 v[46:47], v2 offset:2560
    s_waitcnt lgkmcnt(0)
    v_mfma_f32_32x32x16_bf16 v[128:143], v[32:35], a[16:19], v[128:143]
    v_mfma_f32_32x32x16_bf16 v[144:159], v[36:39], a[16:19], v[144:159]
    v_mfma_f32_32x32x16_bf16 v[128:143], v[40:43], a[20:23], v[128:143]
    v_mfma_f32_32x32x16_bf16 v[144:159], v[44:47], a[20:23], v[144:159]
    s_add_u32 m0, s96, 4096
    s_add_u32 s64, s62, 1310720
    buffer_load_dwordx4 v237, s[28:31], s64 offen offset:0 lds
    s_add_u32 s64, s62, 1375232
    buffer_load_dwordx4 v237, s[28:31], s64 offen offset:1024 lds
    s_add_u32 s64, s62, 1439744
    buffer_load_dwordx4 v237, s[28:31], s64 offen offset:2048 lds
    s_add_u32 s64, s62, 1504256
    buffer_load_dwordx4 v237, s[28:31], s64 offen offset:3072 lds
    s_waitcnt vmcnt(8)
    s_add_u32 s64, s66, 0
    v_add_u32 v1, s64, v243
    v_xor_b32 v2, 64, v1
    ds_read_b64_tr_b16 v[48:49], v1 offset:0
    ds_read_b64_tr_b16 v[50:51], v1 offset:512
    ds_read_b64_tr_b16 v[52:53], v2 offset:0
    ds_read_b64_tr_b16 v[54:55], v2 offset:512
    ds_read_b64_tr_b16 v[56:57], v1 offset:2048
    ds_read_b64_tr_b16 v[58:59], v1 offset:2560
    ds_read_b64_tr_b16 v[60:61], v2 offset:2048
    ds_read_b64_tr_b16 v[62:63], v2 offset:2560
    s_waitcnt lgkmcnt(0)
    v_mfma_f32_32x32x16_bf16 v[128:143], v[48:51], a[24:27], v[128:143]
    v_mfma_f32_32x32x16_bf16 v[144:159], v[52:55], a[24:27], v[144:159]
    v_mfma_f32_32x32x16_bf16 v[128:143], v[56:59], a[28:31], v[128:143]
    v_mfma_f32_32x32x16_bf16 v[144:159], v[60:63], a[28:31], v[144:159]
    s_add_u32 m0, s66, 0
    s_add_u32 s64, s62, 1572864
    buffer_load_dwordx4 v237, s[28:31], s64 offen offset:0 lds
    s_add_u32 s64, s62, 1637376
    buffer_load_dwordx4 v237, s[28:31], s64 offen offset:1024 lds
    s_add_u32 s64, s62, 1701888
    buffer_load_dwordx4 v237, s[28:31], s64 offen offset:2048 lds
    s_add_u32 s64, s62, 1766400
    buffer_load_dwordx4 v237, s[28:31], s64 offen offset:3072 lds
    s_waitcnt vmcnt(8)
    s_add_u32 s64, s96, 0
    v_add_u32 v1, s64, v243
    v_xor_b32 v2, 64, v1
    ds_read_b64_tr_b16 v[32:33], v1 offset:0
    ds_read_b64_tr_b16 v[34:35], v1 offset:512
    ds_read_b64_tr_b16 v[36:37], v2 offset:0
    ds_read_b64_tr_b16 v[38:39], v2 offset:512
    ds_read_b64_tr_b16 v[40:41], v1 offset:2048
    ds_read_b64_tr_b16 v[42:43], v1 offset:2560
    ds_read_b64_tr_b16 v[44:45], v2 offset:2048
    ds_read_b64_tr_b16 v[46:47], v2 offset:2560
    s_waitcnt lgkmcnt(0)
    v_mfma_f32_32x32x16_bf16 v[128:143], v[32:35], a[32:35], v[128:143]
    v_mfma_f32_32x32x16_bf16 v[144:159], v[36:39], a[32:35], v[144:159]
    v_mfma_f32_32x32x16_bf16 v[128:143], v[40:43], a[36:39], v[128:143]
    v_mfma_f32_32x32x16_bf16 v[144:159], v[44:47], a[36:39], v[144:159]
    s_add_u32 m0, s96, 0
    s_add_u32 s64, s62, 1835008
    buffer_load_dwordx4 v237, s[28:31], s64 offen offset:0 lds
    s_add_u32 s64, s62, 1899520
    buffer_load_dwordx4 v237, s[28:31], s64 offen offset:1024 lds
    s_add_u32 s64, s62, 1964032
    buffer_load_dwordx4 v237, s[28:31], s64 offen offset:2048 lds
    s_add_u32 s64, s62, 2028544
    buffer_load_dwordx4 v237, s[28:31], s64 offen offset:3072 lds
    s_waitcnt vmcnt(8)
    s_add_u32 s64, s96, 4096
    v_add_u32 v1, s64, v243
    v_xor_b32 v2, 64, v1
    ds_read_b64_tr_b16 v[48:49], v1 offset:0
    ds_read_b64_tr_b16 v[50:51], v1 offset:512
    ds_read_b64_tr_b16 v[52:53], v2 offset:0
    ds_read_b64_tr_b16 v[54:55], v2 offset:512
    ds_read_b64_tr_b16 v[56:57], v1 offset:2048
    ds_read_b64_tr_b16 v[58:59], v1 offset:2560
    ds_read_b64_tr_b16 v[60:61], v2 offset:2048
    ds_read_b64_tr_b16 v[62:63], v2 offset:2560
    s_waitcnt lgkmcnt(0)
    v_mfma_f32_32x32x16_bf16 v[128:143], v[48:51], a[40:43], v[128:143]
    v_mfma_f32_32x32x16_bf16 v[144:159], v[52:55], a[40:43], v[144:159]
    v_mfma_f32_32x32x16_bf16 v[128:143], v[56:59], a[44:47], v[128:143]
    v_mfma_f32_32x32x16_bf16 v[144:159], v[60:63], a[44:47], v[144:159]
    s_add_u32 m0, s96, 4096
    s_add_u32 s64, s62, 2097152
    buffer_load_dwordx4 v237, s[28:31], s64 offen offset:0 lds
    s_add_u32 s64, s62, 2161664
    buffer_load_dwordx4 v237, s[28:31], s64 offen offset:1024 lds
    s_add_u32 s64, s62, 2226176
    buffer_load_dwordx4 v237, s[28:31], s64 offen offset:2048 lds
    s_add_u32 s64, s62, 2290688
    buffer_load_dwordx4 v237, s[28:31], s64 offen offset:3072 lds
    s_waitcnt vmcnt(8)
    s_add_u32 s64, s66, 0
    v_add_u32 v1, s64, v243
    v_xor_b32 v2, 64, v1
    ds_read_b64_tr_b16 v[32:33], v1 offset:0
    ds_read_b64_tr_b16 v[34:35], v1 offset:512
    ds_read_b64_tr_b16 v[36:37], v2 offset:0
    ds_read_b64_tr_b16 v[38:39], v2 offset:512
    ds_read_b64_tr_b16 v[40:41], v1 offset:2048
    ds_read_b64_tr_b16 v[42:43], v1 offset:2560
    ds_read_b64_tr_b16 v[44:45], v2 offset:2048
    ds_read_b64_tr_b16 v[46:47], v2 offset:2560
    s_waitcnt lgkmcnt(0)
    v_mfma_f32_32x32x16_bf16 v[128:143], v[32:35], a[48:51], v[128:143]
    v_mfma_f32_32x32x16_bf16 v[144:159], v[36:39], a[48:51], v[144:159]
    v_mfma_f32_32x32x16_bf16 v[128:143], v[40:43], a[52:55], v[128:143]
    v_mfma_f32_32x32x16_bf16 v[144:159], v[44:47], a[52:55], v[144:159]
    s_add_u32 m0, s66, 0
    s_add_u32 s64, s62, 2359296
    buffer_load_dwordx4 v237, s[28:31], s64 offen offset:0 lds
    s_add_u32 s64, s62, 2423808
    buffer_load_dwordx4 v237, s[28:31], s64 offen offset:1024 lds
    s_add_u32 s64, s62, 2488320
    buffer_load_dwordx4 v237, s[28:31], s64 offen offset:2048 lds
    s_add_u32 s64, s62, 2552832
    buffer_load_dwordx4 v237, s[28:31], s64 offen offset:3072 lds
    s_waitcnt vmcnt(8)
    s_add_u32 s64, s96, 0
    v_add_u32 v1, s64, v243
    v_xor_b32 v2, 64, v1
    ds_read_b64_tr_b16 v[48:49], v1 offset:0
    ds_read_b64_tr_b16 v[50:51], v1 offset:512
    ds_read_b64_tr_b16 v[52:53], v2 offset:0
    ds_read_b64_tr_b16 v[54:55], v2 offset:512
    ds_read_b64_tr_b16 v[56:57], v1 offset:2048
    ds_read_b64_tr_b16 v[58:59], v1 offset:2560
    ds_read_b64_tr_b16 v[60:61], v2 offset:2048
    ds_read_b64_tr_b16 v[62:63], v2 offset:2560
    s_waitcnt lgkmcnt(0)
    v_mfma_f32_32x32x16_bf16 v[128:143], v[48:51], a[56:59], v[128:143]
    v_mfma_f32_32x32x16_bf16 v[144:159], v[52:55], a[56:59], v[144:159]
    v_mfma_f32_32x32x16_bf16 v[128:143], v[56:59], a[60:63], v[128:143]
    v_mfma_f32_32x32x16_bf16 v[144:159], v[60:63], a[60:63], v[144:159]
    s_add_u32 m0, s96, 0
    s_add_u32 s64, s62, 2621440
    buffer_load_dwordx4 v237, s[28:31], s64 offen offset:0 lds
    s_add_u32 s64, s62, 2685952
    buffer_load_dwordx4 v237, s[28:31], s64 offen offset:1024 lds
    s_add_u32 s64, s62, 2750464
    buffer_load_dwordx4 v237, s[28:31], s64 offen offset:2048 lds
    s_add_u32 s64, s62, 2814976
    buffer_load_dwordx4 v237, s[28:31], s64 offen offset:3072 lds
    s_waitcnt vmcnt(8)
    s_add_u32 s64, s96, 4096
    v_add_u32 v1, s64, v243
    v_xor_b32 v2, 64, v1
    ds_read_b64_tr_b16 v[32:33], v1 offset:0
    ds_read_b64_tr_b16 v[34:35], v1 offset:512
    ds_read_b64_tr_b16 v[36:37], v2 offset:0
    ds_read_b64_tr_b16 v[38:39], v2 offset:512
    ds_read_b64_tr_b16 v[40:41], v1 offset:2048
    ds_read_b64_tr_b16 v[42:43], v1 offset:2560
    ds_read_b64_tr_b16 v[44:45], v2 offset:2048
    ds_read_b64_tr_b16 v[46:47], v2 offset:2560
    s_waitcnt lgkmcnt(0)
    v_mfma_f32_32x32x16_bf16 v[128:143], v[32:35], a[64:67], v[128:143]
    v_mfma_f32_32x32x16_bf16 v[144:159], v[36:39], a[64:67], v[144:159]
    v_mfma_f32_32x32x16_bf16 v[128:143], v[40:43], a[68:71], v[128:143]
    v_mfma_f32_32x32x16_bf16 v[144:159], v[44:47], a[68:71], v[144:159]
    s_add_u32 m0, s96, 4096
    s_add_u32 s64, s62, 2883584
    buffer_load_dwordx4 v237, s[28:31], s64 offen offset:0 lds
    s_add_u32 s64, s62, 2948096
    buffer_load_dwordx4 v237, s[28:31], s64 offen offset:1024 lds
    s_add_u32 s64, s62, 3012608
    buffer_load_dwordx4 v237, s[28:31], s64 offen offset:2048 lds
    s_add_u32 s64, s62, 3077120
    buffer_load_dwordx4 v237, s[28:31], s64 offen offset:3072 lds
    s_waitcnt vmcnt(8)
    s_add_u32 s64, s66, 0
    v_add_u32 v1, s64, v243
    v_xor_b32 v2, 64, v1
    ds_read_b64_tr_b16 v[48:49], v1 offset:0
    ds_read_b64_tr_b16 v[50:51], v1 offset:512
    ds_read_b64_tr_b16 v[52:53], v2 offset:0
    ds_read_b64_tr_b16 v[54:55], v2 offset:512
    ds_read_b64_tr_b16 v[56:57], v1 offset:2048
    ds_read_b64_tr_b16 v[58:59], v1 offset:2560
    ds_read_b64_tr_b16 v[60:61], v2 offset:2048
    ds_read_b64_tr_b16 v[62:63], v2 offset:2560
    s_waitcnt lgkmcnt(0)
    v_mfma_f32_32x32x16_bf16 v[128:143], v[48:51], a[72:75], v[128:143]
    v_mfma_f32_32x32x16_bf16 v[144:159], v[52:55], a[72:75], v[144:159]
    v_mfma_f32_32x32x16_bf16 v[128:143], v[56:59], a[76:79], v[128:143]
    v_mfma_f32_32x32x16_bf16 v[144:159], v[60:63], a[76:79], v[144:159]
    s_add_u32 m0, s66, 0
    s_add_u32 s64, s62, 3145728
    buffer_load_dwordx4 v237, s[28:31], s64 offen offset:0 lds
    s_add_u32 s64, s62, 3210240
    buffer_load_dwordx4 v237, s[28:31], s64 offen offset:1024 lds
    s_add_u32 s64, s62, 3274752
    buffer_load_dwordx4 v237, s[28:31], s64 offen offset:2048 lds
    s_add_u32 s64, s62, 3339264
    buffer_load_dwordx4 v237, s[28:31], s64 offen offset:3072 lds
    s_waitcnt vmcnt(8)
    s_add_u32 s64, s96, 0
    v_add_u32 v1, s64, v243
    v_xor_b32 v2, 64, v1
    ds_read_b64_tr_b16 v[32:33], v1 offset:0
    ds_read_b64_tr_b16 v[34:35], v1 offset:512
    ds_read_b64_tr_b16 v[36:37], v2 offset:0
    ds_read_b64_tr_b16 v[38:39], v2 offset:512
    ds_read_b64_tr_b16 v[40:41], v1 offset:2048
    ds_read_b64_tr_b16 v[42:43], v1 offset:2560
    ds_read_b64_tr_b16 v[44:45], v2 offset:2048
    ds_read_b64_tr_b16 v[46:47], v2 offset:2560
    s_waitcnt lgkmcnt(0)
    v_mfma_f32_32x32x16_bf16 v[128:143], v[32:35], a[80:83], v[128:143]
    v_mfma_f32_32x32x16_bf16 v[144:159], v[36:39], a[80:83], v[144:159]
    v_mfma_f32_32x32x16_bf16 v[128:143], v[40:43], a[84:87], v[128:143]
    v_mfma_f32_32x32x16_bf16 v[144:159], v[44:47], a[84:87], v[144:159]
    s_add_u32 m0, s96, 0
    s_add_u32 s64, s62, 3407872
    buffer_load_dwordx4 v237, s[28:31], s64 offen offset:0 lds
    s_add_u32 s64, s62, 3472384
    buffer_load_dwordx4 v237, s[28:31], s64 offen offset:1024 lds
    s_add_u32 s64, s62, 3536896
    buffer_load_dwordx4 v237, s[28:31], s64 offen offset:2048 lds
    s_add_u32 s64, s62, 3601408
    buffer_load_dwordx4 v237, s[28:31], s64 offen offset:3072 lds
    s_waitcnt vmcnt(8)
    s_add_u32 s64, s96, 4096
    v_add_u32 v1, s64, v243
    v_xor_b32 v2, 64, v1
    ds_read_b64_tr_b16 v[48:49], v1 offset:0
    ds_read_b64_tr_b16 v[50:51], v1 offset:512
    ds_read_b64_tr_b16 v[52:53], v2 offset:0
    ds_read_b64_tr_b16 v[54:55], v2 offset:512
    ds_read_b64_tr_b16 v[56:57], v1 offset:2048
    ds_read_b64_tr_b16 v[58:59], v1 offset:2560
    ds_read_b64_tr_b16 v[60:61], v2 offset:2048
    ds_read_b64_tr_b16 v[62:63], v2 offset:2560
    s_waitcnt lgkmcnt(0)
    v_mfma_f32_32x32x16_bf16 v[128:143], v[48:51], a[88:91], v[128:143]
    v_mfma_f32_32x32x16_bf16 v[144:159], v[52:55], a[88:91], v[144:159]
    v_mfma_f32_32x32x16_bf16 v[128:143], v[56:59], a[92:95], v[128:143]
    v_mfma_f32_32x32x16_bf16 v[144:159], v[60:63], a[92:95], v[144:159]
    s_add_u32 m0, s96, 4096
    s_add_u32 s64, s62, 3670016
    buffer_load_dwordx4 v237, s[28:31], s64 offen offset:0 lds
    s_add_u32 s64, s62, 3734528
    buffer_load_dwordx4 v237, s[28:31], s64 offen offset:1024 lds
    s_add_u32 s64, s62, 3799040
    buffer_load_dwordx4 v237, s[28:31], s64 offen offset:2048 lds
    s_add_u32 s64, s62, 3863552
    buffer_load_dwordx4 v237, s[28:31], s64 offen offset:3072 lds
    s_waitcnt vmcnt(8)
    s_add_u32 s64, s66, 0
    v_add_u32 v1, s64, v243
    v_xor_b32 v2, 64, v1
    ds_read_b64_tr_b16 v[32:33], v1 offset:0
    ds_read_b64_tr_b16 v[34:35], v1 offset:512
    ds_read_b64_tr_b16 v[36:37], v2 offset:0
    ds_read_b64_tr_b16 v[38:39], v2 offset:512
    ds_read_b64_tr_b16 v[40:41], v1 offset:2048
    ds_read_b64_tr_b16 v[42:43], v1 offset:2560
    ds_read_b64_tr_b16 v[44:45], v2 offset:2048
    ds_read_b64_tr_b16 v[46:47], v2 offset:2560
    s_waitcnt lgkmcnt(0)
    v_mfma_f32_32x32x16_bf16 v[128:143], v[32:35], a[96:99], v[128:143]
    v_mfma_f32_32x32x16_bf16 v[144:159], v[36:39], a[96:99], v[144:159]
    v_mfma_f32_32x32x16_bf16 v[128:143], v[40:43], a[100:103], v[128:143]
    v_mfma_f32_32x32x16_bf16 v[144:159], v[44:47], a[100:103], v[144:159]
    s_add_u32 m0, s66, 0
    s_add_u32 s64, s62, 3932160
    buffer_load_dwordx4 v237, s[28:31], s64 offen offset:0 lds
    s_add_u32 s64, s62, 3996672
    buffer_load_dwordx4 v237, s[28:31], s64 offen offset:1024 lds
    s_add_u32 s64, s62, 4061184
    buffer_load_dwordx4 v237, s[28:31], s64 offen offset:2048 lds
    s_add_u32 s64, s62, 4125696
    buffer_load_dwordx4 v237, s[28:31], s64 offen offset:3072 lds
    s_waitcnt vmcnt(8)
    s_add_u32 s64, s96, 0
    v_add_u32 v1, s64, v243
    v_xor_b32 v2, 64, v1
    ds_read_b64_tr_b16 v[48:49], v1 offset:0
    ds_read_b64_tr_b16 v[50:51], v1 offset:512
    ds_read_b64_tr_b16 v[52:53], v2 offset:0
    ds_read_b64_tr_b16 v[54:55], v2 offset:512
    ds_read_b64_tr_b16 v[56:57], v1 offset:2048
    ds_read_b64_tr_b16 v[58:59], v1 offset:2560
    ds_read_b64_tr_b16 v[60:61], v2 offset:2048
    ds_read_b64_tr_b16 v[62:63], v2 offset:2560
    s_waitcnt lgkmcnt(0)
    v_mfma_f32_32x32x16_bf16 v[128:143], v[48:51], a[104:107], v[128:143]
    v_mfma_f32_32x32x16_bf16 v[144:159], v[52:55], a[104:107], v[144:159]
    v_mfma_f32_32x32x16_bf16 v[128:143], v[56:59], a[108:111], v[128:143]
    v_mfma_f32_32x32x16_bf16 v[144:159], v[60:63], a[108:111], v[144:159]
    s_add_u32 m0, s96, 0
    s_add_u32 s64, s62, 4194304
    buffer_load_dwordx4 v237, s[28:31], s64 offen offset:0 lds
    s_add_u32 s64, s62, 4258816
    buffer_load_dwordx4 v237, s[28:31], s64 offen offset:1024 lds
    s_add_u32 s64, s62, 4323328
    buffer_load_dwordx4 v237, s[28:31], s64 offen offset:2048 lds
    s_add_u32 s64, s62, 4387840
    buffer_load_dwordx4 v237, s[28:31], s64 offen offset:3072 lds
    s_waitcnt vmcnt(8)
    s_add_u32 s64, s96, 4096
    v_add_u32 v1, s64, v243
    v_xor_b32 v2, 64, v1
    ds_read_b64_tr_b16 v[32:33], v1 offset:0
    ds_read_b64_tr_b16 v[34:35], v1 offset:512
    ds_read_b64_tr_b16 v[36:37], v2 offset:0
    ds_read_b64_tr_b16 v[38:39], v2 offset:512
    ds_read_b64_tr_b16 v[40:41], v1 offset:2048
    ds_read_b64_tr_b16 v[42:43], v1 offset:2560
    ds_read_b64_tr_b16 v[44:45], v2 offset:2048
    ds_read_b64_tr_b16 v[46:47], v2 offset:2560
    s_waitcnt lgkmcnt(0)
    v_mfma_f32_32x32x16_bf16 v[128:143], v[32:35], a[112:115], v[128:143]
    v_mfma_f32_32x32x16_bf16 v[144:159], v[36:39], a[112:115], v[144:159]
    v_mfma_f32_32x32x16_bf16 v[128:143], v[40:43], a[116:119], v[128:143]
    v_mfma_f32_32x32x16_bf16 v[144:159], v[44:47], a[116:119], v[144:159]
    s_add_u32 m0, s96, 4096
    s_add_u32 s64, s62, 4456448
    buffer_load_dwordx4 v237, s[28:31], s64 offen offset:0 lds
    s_add_u32 s64, s62, 4520960
    buffer_load_dwordx4 v237, s[28:31], s64 offen offset:1024 lds
    s_add_u32 s64, s62, 4585472
    buffer_load_dwordx4 v237, s[28:31], s64 offen offset:2048 lds
    s_add_u32 s64, s62, 4649984
    buffer_load_dwordx4 v237, s[28:31], s64 offen offset:3072 lds
    s_waitcnt vmcnt(8)
    s_add_u32 s64, s66, 0
    v_add_u32 v1, s64, v243
    v_xor_b32 v2, 64, v1
    ds_read_b64_tr_b16 v[48:49], v1 offset:0
    ds_read_b64_tr_b16 v[50:51], v1 offset:512
    ds_read_b64_tr_b16 v[52:53], v2 offset:0
    ds_read_b64_tr_b16 v[54:55], v2 offset:512
    ds_read_b64_tr_b16 v[56:57], v1 offset:2048
    ds_read_b64_tr_b16 v[58:59], v1 offset:2560
    ds_read_b64_tr_b16 v[60:61], v2 offset:2048
    ds_read_b64_tr_b16 v[62:63], v2 offset:2560
    s_waitcnt lgkmcnt(0)
    v_mfma_f32_32x32x16_bf16 v[128:143], v[48:51], a[120:123], v[128:143]
    v_mfma_f32_32x32x16_bf16 v[144:159], v[52:55], a[120:123], v[144:159]
    v_mfma_f32_32x32x16_bf16 v[128:143], v[56:59], a[124:127], v[128:143]
    v_mfma_f32_32x32x16_bf16 v[144:159], v[60:63], a[124:127], v[144:159]
    s_mov_b32 m0, s79
    s_nop 0
    buffer_load_dwordx4 v236, s[24:27], s78 offen offset:0 nt lds
    buffer_load_dwordx4 v236, s[24:27], s78 offen offset:1024 nt lds
    buffer_load_dwordx4 v236, s[24:27], s78 offen offset:2048 nt lds
    buffer_load_dwordx4 v236, s[24:27], s78 offen offset:3072 nt lds
    s_waitcnt vmcnt(8)
    s_add_u32 s64, s96, 0
    v_add_u32 v1, s64, v243
    v_xor_b32 v2, 64, v1
    ds_read_b64_tr_b16 v[32:33], v1 offset:0
    ds_read_b64_tr_b16 v[34:35], v1 offset:512
    ds_read_b64_tr_b16 v[36:37], v2 offset:0
    ds_read_b64_tr_b16 v[38:39], v2 offset:512
    ds_read_b64_tr_b16 v[40:41], v1 offset:2048
    ds_read_b64_tr_b16 v[42:43], v1 offset:2560
    ds_read_b64_tr_b16 v[44:45], v2 offset:2048
    ds_read_b64_tr_b16 v[46:47], v2 offset:2560
    s_waitcnt lgkmcnt(0)
    v_mfma_f32_32x32x16_bf16 v[128:143], v[32:35], a[128:131], v[128:143]
    v_mfma_f32_32x32x16_bf16 v[144:159], v[36:39], a[128:131], v[144:159]
    v_mfma_f32_32x32x16_bf16 v[128:143], v[40:43], a[132:135], v[128:143]
    v_mfma_f32_32x32x16_bf16 v[144:159], v[44:47], a[132:135], v[144:159]
    s_waitcnt vmcnt(4)
    s_add_u32 s64, s96, 4096
    v_add_u32 v1, s64, v243
    v_xor_b32 v2, 64, v1
    ds_read_b64_tr_b16 v[48:49], v1 offset:0
    ds_read_b64_tr_b16 v[50:51], v1 offset:512
    ds_read_b64_tr_b16 v[52:53], v2 offset:0
    ds_read_b64_tr_b16 v[54:55], v2 offset:512
    ds_read_b64_tr_b16 v[56:57], v1 offset:2048
    ds_read_b64_tr_b16 v[58:59], v1 offset:2560
    ds_read_b64_tr_b16 v[60:61], v2 offset:2048
    ds_read_b64_tr_b16 v[62:63], v2 offset:2560
    s_waitcnt lgkmcnt(0)
    v_mfma_f32_32x32x16_bf16 v[128:143], v[48:51], a[136:139], v[128:143]
    v_mfma_f32_32x32x16_bf16 v[144:159], v[52:55], a[136:139], v[144:159]
    v_mfma_f32_32x32x16_bf16 v[128:143], v[56:59], a[140:143], v[128:143]
    v_mfma_f32_32x32x16_bf16 v[144:159], v[60:63], a[140:143], v[144:159]
    s_add_u32 s66, s71, 135168
    v_and_b32 v1, 31, v0
    v_lshlrev_b32 v1, 4, v1
    v_lshrrev_b32 v3, 5, v0
    v_lshl_add_u32 v1, v3, 3, v1
    v_add_u32 v1, s66, v1
    s_nop 5
    v_cvt_pk_bf16_f32 v128, v128, v129
    v_cvt_pk_bf16_f32 v129, v130, v131
    ds_write_b64 v1, v[128:129] offset:0
    v_cvt_pk_bf16_f32 v132, v132, v133
    v_cvt_pk_bf16_f32 v133, v134, v135
    ds_write_b64 v1, v[132:133] offset:512
    v_cvt_pk_bf16_f32 v136, v136, v137
    v_cvt_pk_bf16_f32 v137, v138, v139
    ds_write_b64 v1, v[136:137] offset:1024
    v_cvt_pk_bf16_f32 v140, v140, v141
    v_cvt_pk_bf16_f32 v141, v142, v143
    ds_write_b64 v1, v[140:141] offset:1536
    v_cvt_pk_bf16_f32 v144, v144, v145
    v_cvt_pk_bf16_f32 v145, v146, v147
    ds_write_b64 v1, v[144:145] offset:2048
    v_cvt_pk_bf16_f32 v148, v148, v149
    v_cvt_pk_bf16_f32 v149, v150, v151
    ds_write_b64 v1, v[148:149] offset:2560
    v_cvt_pk_bf16_f32 v152, v152, v153
    v_cvt_pk_bf16_f32 v153, v154, v155
    ds_write_b64 v1, v[152:153] offset:3072
    v_cvt_pk_bf16_f32 v156, v156, v157
    v_cvt_pk_bf16_f32 v157, v158, v159
    ds_write_b64 v1, v[156:157] offset:3584
    s_waitcnt lgkmcnt(0)
    s_barrier
    s_and_b32 s64, s52, 1
    s_lshl_b32 s64, s64, 13
    s_add_u32 s64, s64, 135168
    v_lshl_add_u32 v1, v0, 4, s64
    ds_read_b128 v[200:203], v1 offset:0
    ds_read_b128 v[204:207], v1 offset:1024
    ds_read_b128 v[208:211], v1 offset:2048
    ds_read_b128 v[212:215], v1 offset:3072
    ds_read_b128 v[216:219], v1 offset:4096
    ds_read_b128 v[220:223], v1 offset:5120
    ds_read_b128 v[224:227], v1 offset:6144
    ds_read_b128 v[228:231], v1 offset:7168
L_ALT1E:
    s_waitcnt vmcnt(12)
    s_barrier
    s_bitcmp1_b32 s53, 0
    s_cbranch_scc1 L_ALT2B
    s_call_b64 s[58:59], L_STEPQ
    s_branch L_ALT2E
L_ALT2B:
    s_call_b64 s[58:59], L_STEPQ_NV
L_ALT2E:
    s_waitcnt vmcnt(16)
    s_barrier
    s_call_b64 s[58:59], L_STEPQ
    s_waitcnt vmcnt(12)
    s_barrier
    s_add_u32 s64, s61, 0
    v_add_u32 v1, s64, v243
    v_xor_b32 v2, 64, v1
    ds_read_b64_tr_b16 a[144:145], v1 offset:0
    ds_read_b64_tr_b16 a[146:147], v1 offset:512
    ds_read_b64_tr_b16 a[148:149], v2 offset:0
    ds_read_b64_tr_b16 a[150:151], v2 offset:512
    ds_read_b64_tr_b16 a[152:153], v1 offset:2048
    ds_read_b64_tr_b16 a[154:155], v1 offset:2560
    ds_read_b64_tr_b16 a[156:157], v2 offset:2048
    ds_read_b64_tr_b16 a[158:159], v2 offset:2560
    s_call_b64 s[58:59], L_STEPQ
    v_mfma_f32_32x32x16_bf16 v[128:143], a[144:147], a[0:3], 0
    v_mfma_f32_32x32x16_bf16 v[144:159], a[148:151], a[0:3], 0
    v_mfma_f32_32x32x16_bf16 v[128:143], a[152:155], a[4:7], v[128:143]
    v_mfma_f32_32x32x16_bf16 v[144:159], a[156:159], a[4:7], v[144:159]
    s_waitcnt vmcnt(12)
    s_barrier
    s_add_u32 s64, s61, 18432
    v_add_u32 v1, s64, v243
    v_xor_b32 v2, 64, v1
    ds_read_b64_tr_b16 a[160:161], v1 offset:0
    ds_read_b64_tr_b16 a[162:163], v1 offset:512
    ds_read_b64_tr_b16 a[164:165], v2 offset:0
    ds_read_b64_tr_b16 a[166:167], v2 offset:512
    ds_read_b64_tr_b16 a[168:169], v1 offset:2048
    ds_read_b64_tr_b16 a[170:171], v1 offset:2560
    ds_read_b64_tr_b16 a[172:173], v2 offset:2048
    ds_read_b64_tr_b16 a[174:175], v2 offset:2560
    s_call_b64 s[58:59], L_STEPQ
    v_mfma_f32_32x32x16_bf16 v[128:143], a[160:163], a[8:11], v[128:143]
    v_mfma_f32_32x32x16_bf16 v[144:159], a[164:167], a[8:11], v[144:159]
    v_mfma_f32_32x32x16_bf16 v[128:143], a[168:171], a[12:15], v[128:143]
    v_mfma_f32_32x32x16_bf16 v[144:159], a[172:175], a[12:15], v[144:159]
    s_waitcnt vmcnt(12)
    s_barrier
    s_add_u32 s64, s61, 0
    v_add_u32 v1, s64, v243
    v_xor_b32 v2, 64, v1
    ds_read_b64_tr_b16 a[144:145], v1 offset:0
    ds_read_b64_tr_b16 a[146:147], v1 offset:512
    ds_read_b64_tr_b16 a[148:149], v2 offset:0
    ds_read_b64_tr_b16 a[150:151], v2 offset:512
    ds_read_b64_tr_b16 a[152:153], v1 offset:2048
    ds_read_b64_tr_b16 a[154:155], v1 offset:2560
    ds_read_b64_tr_b16 a[156:157], v2 offset:2048
    ds_read_b64_tr_b16 a[158:159], v2 offset:2560
    s_call_b64 s[58:59], L_STEPQ
    v_mfma_f32_32x32x16_bf16 v[128:143], a[144:147], a[16:19], v[128:143]
    v_mfma_f32_32x32x16_bf16 v[144:159], a[148:151], a[16:19], v[144:159]
    v_mfma_f32_32x32x16_bf16 v[128:143], a[152:155], a[20:23], v[128:143]
    v_mfma_f32_32x32x16_bf16 v[144:159], a[156:159], a[20:23], v[144:159]
    s_waitcnt vmcnt(12)
    s_barrier
    s_add_u32 s64, s61, 18432
    v_add_u32 v1, s64, v243
    v_xor_b32 v2, 64, v1
    ds_read_b64_tr_b16 a[160:161], v1 offset:0
    ds_read_b64_tr_b16 a[162:163], v1 offset:512
    ds_read_b64_tr_b16 a[164:165], v2 offset:0
    ds_read_b64_tr_b16 a[166:167], v2 offset:512
    ds_read_b64_tr_b16 a[168:169], v1 offset:2048
    ds_read_b64_tr_b16 a[170:171], v1 offset:2560
    ds_read_b64_tr_b16 a[172:173], v2 offset:2048
    ds_read_b64_tr_b16 a[174:175], v2 offset:2560
    s_call_b64 s[58:59], L_STEPQ
    v_mfma_f32_32x32x16_bf16 v[128:143], a[160:163], a[24:27], v[128:143]
    v_mfma_f32_32x32x16_bf16 v[144:159], a[164:167], a[24:27], v[144:159]
    v_mfma_f32_32x32x16_bf16 v[128:143], a[168:171], a[28:31], v[128:143]
    v_mfma_f32_32x32x16_bf16 v[144:159], a[172:175], a[28:31], v[144:159]
    s_waitcnt vmcnt(12)
    s_barrier
    s_add_u32 s64, s61, 0
    v_add_u32 v1, s64, v243
    v_xor_b32 v2, 64, v1
    ds_read_b64_tr_b16 a[144:145], v1 offset:0
    ds_read_b64_tr_b16 a[146:147], v1 offset:512
    ds_read_b64_tr_b16 a[148:149], v2 offset:0
    ds_read_b64_tr_b16 a[150:151], v2 offset:512
    ds_read_b64_tr_b16 a[152:153], v1 offset:2048
    ds_read_b64_tr_b16 a[154:155], v1 offset:2560
    ds_read_b64_tr_b16 a[156:157], v2 offset:2048
    ds_read_b64_tr_b16 a[158:159], v2 offset:2560
    s_call_b64 s[58:59], L_STEPQ
    v_mfma_f32_32x32x16_bf16 v[128:143], a[144:147], a[32:35], v[128:143]
    v_mfma_f32_32x32x16_bf16 v[144:159], a[148:151], a[32:35], v[144:159]
    v_mfma_f32_32x32x16_bf16 v[128:143], a[152:155], a[36:39], v[128:143]
    v_mfma_f32_32x32x16_bf16 v[144:159], a[156:159], a[36:39], v[144:159]
    s_waitcnt vmcnt(12)
    s_barrier
    s_add_u32 s64, s61, 18432
    v_add_u32 v1, s64, v243
    v_xor_b32 v2, 64, v1
    ds_read_b64_tr_b16 a[160:161], v1 offset:0
    ds_read_b64_tr_b16 a[162:163], v1 offset:512
    ds_read_b64_tr_b16 a[164:165], v2 offset:0
    ds_read_b64_tr_b16 a[166:167], v2 offset:512
    ds_read_b64_tr_b16 a[168:169], v1 offset:2048
    ds_read_b64_tr_b16 a[170:171], v1 offset:2560
    ds_read_b64_tr_b16 a[172:173], v2 offset:2048
    ds_read_b64_tr_b16 a[174:175], v2 offset:2560
    s_call_b64 s[58:59], L_STEPQ
    v_mfma_f32_32x32x16_bf16 v[128:143], a[160:163], a[40:43], v[128:143]
    v_mfma_f32_32x32x16_bf16 v[144:159], a[164:167], a[40:43], v[144:159]
    v_mfma_f32_32x32x16_bf16 v[128:143], a[168:171], a[44:47], v[128:143]
    v_mfma_f32_32x32x16_bf16 v[144:159], a[172:175], a[44:47], v[144:159]
    s_waitcnt vmcnt(12)
    s_barrier
    s_add_u32 s64, s61, 0
    v_add_u32 v1, s64, v243
    v_xor_b32 v2, 64, v1
    ds_read_b64_tr_b16 a[144:145], v1 offset:0
    ds_read_b64_tr_b16 a[146:147], v1 offset:512
    ds_read_b64_tr_b16 a[148:149], v2 offset:0
    ds_read_b64_tr_b16 a[150:151], v2 offset:512
    ds_read_b64_tr_b16 a[152:153], v1 offset:2048
    ds_read_b64_tr_b16 a[154:155], v1 offset:2560
    ds_read_b64_tr_b16 a[156:157], v2 offset:2048
    ds_read_b64_tr_b16 a[158:159], v2 offset:2560
    s_call_b64 s[58:59], L_STEPQ
    v_mfma_f32_32x32x16_bf16 v[128:143], a[144:147], a[48:51], v[128:143]
    v_mfma_f32_32x32x16_bf16 v[144:159], a[148:151], a[48:51], v[144:159]
    v_mfma_f32_32x32x16_bf16 v[128:143], a[152:155], a[52:55], v[128:143]
    v_mfma_f32_32x32x16_bf16 v[144:159], a[156:159], a[52:55], v[144:159]
    s_waitcnt vmcnt(12)
    s_barrier
    s_add_u32 s64, s61, 18432
    v_add_u32 v1, s64, v243
    v_xor_b32 v2, 64, v1
    ds_read_b64_tr_b16 a[160:161], v1 offset:0
    ds_read_b64_tr_b16 a[162:163], v1 offset:512
    ds_read_b64_tr_b16 a[164:165], v2 offset:0
    ds_read_b64_tr_b16 a[166:167], v2 offset:512
    ds_read_b64_tr_b16 a[168:169], v1 offset:2048
    ds_read_b64_tr_b16 a[170:171], v1 offset:2560
    ds_read_b64_tr_b16 a[172:173], v2 offset:2048
    ds_read_b64_tr_b16 a[174:175], v2 offset:2560
    s_call_b64 s[58:59], L_STEPQ
    v_mfma_f32_32x32x16_bf16 v[128:143], a[160:163], a[56:59], v[128:143]
    v_mfma_f32_32x32x16_bf16 v[144:159], a[164:167], a[56:59], v[144:159]
    v_mfma_f32_32x32x16_bf16 v[128:143], a[168:171], a[60:63], v[128:143]
    v_mfma_f32_32x32x16_bf16 v[144:159], a[172:175], a[60:63], v[144:159]
    s_waitcnt vmcnt(12)
    s_barrier
    s_add_u32 s64, s61, 0
    v_add_u32 v1, s64, v243
    v_xor_b32 v2, 64, v1
    ds_read_b64_tr_b16 a[144:145], v1 offset:0
    ds_read_b64_tr_b16 a[146:147], v1 offset:512
    ds_read_b64_tr_b16 a[148:149], v2 offset:0
    ds_read_b64_tr_b16 a[150:151], v2 offset:512
    ds_read_b64_tr_b16 a[152:153], v1 offset:2048
    ds_read_b64_tr_b16 a[154:155], v1 offset:2560
    ds_read_b64_tr_b16 a[156:157], v2 offset:2048
    ds_read_b64_tr_b16 a[158:159], v2 offset:2560
    s_call_b64 s[58:59], L_STEPQ
    v_mfma_f32_32x32x16_bf16 v[128:143], a[144:147], a[64:67], v[128:143]
    v_mfma_f32_32x32x16_bf16 v[144:159], a[148:151], a[64:67], v[144:159]
    v_mfma_f32_32x32x16_bf16 v[128:143], a[152:155], a[68:71], v[128:143]
    v_mfma_f32_32x32x16_bf16 v[144:159], a[156:159], a[68:71], v[144:159]
    s_waitcnt vmcnt(12)
    s_barrier
    s_add_u32 s64, s61, 18432
    v_add_u32 v1, s64, v243
    v_xor_b32 v2, 64, v1
    ds_read_b64_tr_b16 a[160:161], v1 offset:0
    ds_read_b64_tr_b16 a[162:163], v1 offset:512
    ds_read_b64_tr_b16 a[164:165], v2 offset:0
    ds_read_b64_tr_b16 a[166:167], v2 offset:512
    ds_read_b64_tr_b16 a[168:169], v1 offset:2048
    ds_read_b64_tr_b16 a[170:171], v1 offset:2560
    ds_read_b64_tr_b16 a[172:173], v2 offset:2048
    ds_read_b64_tr_b16 a[174:175], v2 offset:2560
    s_call_b64 s[58:59], L_STEPQ
    v_mfma_f32_32x32x16_bf16 v[128:143], a[160:163], a[72:75], v[128:143]
    v_mfma_f32_32x32x16_bf16 v[144:159], a[164:167], a[72:75], v[144:159]
    v_mfma_f32_32x32x16_bf16 v[128:143], a[168:171], a[76:79], v[128:143]
    v_mfma_f32_32x32x16_bf16 v[144:159], a[172:175], a[76:79], v[144:159]
    s_waitcnt vmcnt(12)
    s_barrier
    s_add_u32 s64, s61, 0
    v_add_u32 v1, s64, v243
    v_xor_b32 v2, 64, v1
    ds_read_b64_tr_b16 a[144:145], v1 offset:0
    ds_read_b64_tr_b16 a[146:147], v1 offset:512
    ds_read_b64_tr_b16 a[148:149], v2 offset:0
    ds_read_b64_tr_b16 a[150:151], v2 offset:512
    ds_read_b64_tr_b16 a[152:153], v1 offset:2048
    ds_read_b64_tr_b16 a[154:155], v1 offset:2560
    ds_read_b64_tr_b16 a[156:157], v2 offset:2048
    ds_read_b64_tr_b16 a[158:159], v2 offset:2560
    s_call_b64 s[58:59], L_STEPQ
    v_mfma_f32_32x32x16_bf16 v[128:143], a[144:147], a[80:83], v[128:143]
    v_mfma_f32_32x32x16_bf16 v[144:159], a[148:151], a[80:83], v[144:159]
    v_mfma_f32_32x32x16_bf16 v[128:143], a[152:155], a[84:87], v[128:143]
    v_mfma_f32_32x32x16_bf16 v[144:159], a[156:159], a[84:87], v[144:159]
    s_waitcnt vmcnt(12)
    s_barrier
    s_add_u32 s64, s61, 18432
    v_add_u32 v1, s64, v243
    v_xor_b32 v2, 64, v1
    ds_read_b64_tr_b16 a[160:161], v1 offset:0
    ds_read_b64_tr_b16 a[162:163], v1 offset:512
    ds_read_b64_tr_b16 a[164:165], v2 offset:0
    ds_read_b64_tr_b16 a[166:167], v2 offset:512
    ds_read_b64_tr_b16 a[168:169], v1 offset:2048
    ds_read_b64_tr_b16 a[170:171], v1 offset:2560
    ds_read_b64_tr_b16 a[172:173], v2 offset:2048
    ds_read_b64_tr_b16 a[174:175], v2 offset:2560
    s_call_b64 s[58:59], L_STEPQ
    v_mfma_f32_32x32x16_bf16 v[128:143], a[160:163], a[88:91], v[128:143]
    v_mfma_f32_32x32x16_bf16 v[144:159], a[164:167], a[88:91], v[144:159]
    v_mfma_f32_32x32x16_bf16 v[128:143], a[168:171], a[92:95], v[128:143]
    v_mfma_f32_32x32x16_bf16 v[144:159], a[172:175], a[92:95], v[144:159]
    s_waitcnt vmcnt(12)
    s_barrier
    s_add_u32 s64, s61, 0
    v_add_u32 v1, s64, v243
    v_xor_b32 v2, 64, v1
    ds_read_b64_tr_b16 a[144:145], v1 offset:0
    ds_read_b64_tr_b16 a[146:147], v1 offset:512
    ds_read_b64_tr_b16 a[148:149], v2 offset:0
    ds_read_b64_tr_b16 a[150:151], v2 offset:512
    ds_read_b64_tr_b16 a[152:153], v1 offset:2048
    ds_read_b64_tr_b16 a[154:155], v1 offset:2560
    ds_read_b64_tr_b16 a[156:157], v2 offset:2048
    ds_read_b64_tr_b16 a[158:159], v2 offset:2560
    s_call_b64 s[58:59], L_STEPQ
    v_mfma_f32_32x32x16_bf16 v[128:143], a[144:147], a[96:99], v[128:143]
    v_mfma_f32_32x32x16_bf16 v[144:159], a[148:151], a[96:99], v[144:159]
    v_mfma_f32_32x32x16_bf16 v[128:143], a[152:155], a[100:103], v[128:143]
    v_mfma_f32_32x32x16_bf16 v[144:159], a[156:159], a[100:103], v[144:159]
    s_waitcnt vmcnt(12)
    s_barrier
    s_add_u32 s64, s61, 18432
    v_add_u32 v1, s64, v243
    v_xor_b32 v2, 64, v1
    ds_read_b64_tr_b16 a[160:161], v1 offset:0
    ds_read_b64_tr_b16 a[162:163], v1 offset:512
    ds_read_b64_tr_b16 a[164:165], v2 offset:0
    ds_read_b64_tr_b16 a[166:167], v2 offset:512
    ds_read_b64_tr_b16 a[168:169], v1 offset:2048
    ds_read_b64_tr_b16 a[170:171], v1 offset:2560
    ds_read_b64_tr_b16 a[172:173], v2 offset:2048
    ds_read_b64_tr_b16 a[174:175], v2 offset:2560
    s_call_b64 s[58:59], L_STEPQ
    v_mfma_f32_32x32x16_bf16 v[128:143], a[160:163], a[104:107], v[128:143]
    v_mfma_f32_32x32x16_bf16 v[144:159], a[164:167], a[104:107], v[144:159]
    v_mfma_f32_32x32x16_bf16 v[128:143], a[168:171], a[108:111], v[128:143]
    v_mfma_f32_32x32x16_bf16 v[144:159], a[172:175], a[108:111], v[144:159]
    s_waitcnt vmcnt(12)
    s_barrier
    s_add_u32 s64, s61, 0
    v_add_u32 v1, s64, v243
    v_xor_b32 v2, 64, v1
    ds_read_b64_tr_b16 a[144:145], v1 offset:0
    ds_read_b64_tr_b16 a[146:147], v1 offset:512
    ds_read_b64_tr_b16 a[148:149], v2 offset:0
    ds_read_b64_tr_b16 a[150:151], v2 offset:512
    ds_read_b64_tr_b16 a[152:153], v1 offset:2048
    ds_read_b64_tr_b16 a[154:155], v1 offset:2560
    ds_read_b64_tr_b16 a[156:157], v2 offset:2048
    ds_read_b64_tr_b16 a[158:159], v2 offset:2560
    s_call_b64 s[58:59], L_STEPQ
    v_mfma_f32_32x32x16_bf16 v[128:143], a[144:147], a[112:115], v[128:143]
    v_mfma_f32_32x32x16_bf16 v[144:159], a[148:151], a[112:115], v[144:159]
    v_mfma_f32_32x32x16_bf16 v[128:143], a[152:155], a[116:119], v[128:143]
    v_mfma_f32_32x32x16_bf16 v[144:159], a[156:159], a[116:119], v[144:159]
    s_waitcnt vmcnt(12)
    s_barrier
    s_add_u32 s64, s61, 18432
    v_add_u32 v1, s64, v243
    v_xor_b32 v2, 64, v1
    ds_read_b64_tr_b16 a[160:161], v1 offset:0
    ds_read_b64_tr_b16 a[162:163], v1 offset:512
    ds_read_b64_tr_b16 a[164:165], v2 offset:0
    ds_read_b64_tr_b16 a[166:167], v2 offset:512
    ds_read_b64_tr_b16 a[168:169], v1 offset:2048
    ds_read_b64_tr_b16 a[170:171], v1 offset:2560
    ds_read_b64_tr_b16 a[172:173], v2 offset:2048
    ds_read_b64_tr_b16 a[174:175], v2 offset:2560
    s_call_b64 s[58:59], L_STEPQ
    v_mfma_f32_32x32x16_bf16 v[128:143], a[160:163], a[120:123], v[128:143]
    v_mfma_f32_32x32x16_bf16 v[144:159], a[164:167], a[120:123], v[144:159]
    v_mfma_f32_32x32x16_bf16 v[128:143], a[168:171], a[124:127], v[128:143]
    v_mfma_f32_32x32x16_bf16 v[144:159], a[172:175], a[124:127], v[144:159]
    s_waitcnt vmcnt(12)
    s_barrier
    s_add_u32 s64, s61, 0
    v_add_u32 v1, s64, v243
    v_xor_b32 v2, 64, v1
    ds_read_b64_tr_b16 a[144:145], v1 offset:0
    ds_read_b64_tr_b16 a[146:147], v1 offset:512
    ds_read_b64_tr_b16 a[148:149], v2 offset:0
    ds_read_b64_tr_b16 a[150:151], v2 offset:512
    ds_read_b64_tr_b16 a[152:153], v1 offset:2048
    ds_read_b64_tr_b16 a[154:155], v1 offset:2560
    ds_read_b64_tr_b16 a[156:157], v2 offset:2048
    ds_read_b64_tr_b16 a[158:159], v2 offset:2560
    s_mov_b32 s74, s63
    s_call_b64 s[58:59], L_STEPO
    v_mfma_f32_32x32x16_bf16 v[128:143], a[144:147], a[128:131], v[128:143]
    v_mfma_f32_32x32x16_bf16 v[144:159], a[148:151], a[128:131], v[144:159]
    v_mfma_f32_32x32x16_bf16 v[128:143], a[152:155], a[132:135], v[128:143]
    v_mfma_f32_32x32x16_bf16 v[144:159], a[156:159], a[132:135], v[144:159]
    s_waitcnt vmcnt(13)
    s_barrier
    s_add_u32 s64, s61, 18432
    v_add_u32 v1, s64, v243
    v_xor_b32 v2, 64, v1
    ds_read_b64_tr_b16 a[160:161], v1 offset:0
    ds_read_b64_tr_b16 a[162:163], v1 offset:512
    ds_read_b64_tr_b16 a[164:165], v2 offset:0
    ds_read_b64_tr_b16 a[166:167], v2 offset:512
    ds_read_b64_tr_b16 a[168:169], v1 offset:2048
    ds_read_b64_tr_b16 a[170:171], v1 offset:2560
    ds_read_b64_tr_b16 a[172:173], v2 offset:2048
    ds_read_b64_tr_b16 a[174:175], v2 offset:2560
    s_call_b64 s[58:59], L_STEPO
    v_mfma_f32_32x32x16_bf16 v[128:143], a[160:163], a[136:139], v[128:143]
    v_mfma_f32_32x32x16_bf16 v[144:159], a[164:167], a[136:139], v[144:159]
    v_mfma_f32_32x32x16_bf16 v[128:143], a[168:171], a[140:143], v[128:143]
    v_mfma_f32_32x32x16_bf16 v[144:159], a[172:175], a[140:143], v[144:159]
    s_waitcnt vmcnt(13)
    s_barrier
    ds_read_b64_tr_b16 a[0:1], v248 offset:0
    ds_read_b64_tr_b16 a[4:5], v249 offset:0
    ds_read_b64_tr_b16 a[8:9], v250 offset:0
    ds_read_b64_tr_b16 a[12:13], v251 offset:0
    ds_read_b64_tr_b16 a[16:17], v248 offset:128
    ds_read_b64_tr_b16 a[20:21], v249 offset:128
    ds_read_b64_tr_b16 a[24:25], v250 offset:128
    ds_read_b64_tr_b16 a[28:29], v251 offset:128
    ds_read_b64_tr_b16 a[32:33], v248 offset:256
    s_call_b64 s[58:59], L_STEPO
    s_waitcnt vmcnt(13)
    s_barrier
    ds_read_b64_tr_b16 a[2:3], v248 offset:18432
    ds_read_b64_tr_b16 a[6:7], v249 offset:18432
    ds_read_b64_tr_b16 a[10:11], v250 offset:18432
    ds_read_b64_tr_b16 a[14:15], v251 offset:18432
    ds_read_b64_tr_b16 a[18:19], v248 offset:18560
    ds_read_b64_tr_b16 a[22:23], v249 offset:18560
    ds_read_b64_tr_b16 a[26:27], v250 offset:18560
    ds_read_b64_tr_b16 a[30:31], v251 offset:18560
    ds_read_b64_tr_b16 a[34:35], v248 offset:18688
    s_call_b64 s[58:59], L_STEPO
    s_waitcnt vmcnt(13)
    s_barrier
    ds_read_b64_tr_b16 a[36:37], v248 offset:0
    ds_read_b64_tr_b16 a[40:41], v249 offset:0
    ds_read_b64_tr_b16 a[44:45], v250 offset:0
    ds_read_b64_tr_b16 a[48:49], v251 offset:0
    ds_read_b64_tr_b16 a[52:53], v248 offset:128
    ds_read_b64_tr_b16 a[56:57], v249 offset:128
    ds_read_b64_tr_b16 a[60:61], v250 offset:128
    ds_read_b64_tr_b16 a[64:65], v251 offset:128
    ds_read_b64_tr_b16 a[68:69], v248 offset:256
    s_call_b64 s[58:59], L_STEPO
    s_waitcnt vmcnt(13)
    s_barrier
    ds_read_b64_tr_b16 a[38:39], v248 offset:18432
    ds_read_b64_tr_b16 a[42:43], v249 offset:18432
    ds_read_b64_tr_b16 a[46:47], v250 offset:18432
    ds_read_b64_tr_b16 a[50:51], v251 offset:18432
    ds_read_b64_tr_b16 a[54:55], v248 offset:18560
    ds_read_b64_tr_b16 a[58:59], v249 offset:18560
    ds_read_b64_tr_b16 a[62:63], v250 offset:18560
    ds_read_b64_tr_b16 a[66:67], v251 offset:18560
    ds_read_b64_tr_b16 a[70:71], v248 offset:18688
    s_call_b64 s[58:59], L_STEPO
    s_waitcnt vmcnt(13)
    s_barrier
    ds_read_b64_tr_b16 a[72:73], v248 offset:0
    ds_read_b64_tr_b16 a[76:77], v249 offset:0
    ds_read_b64_tr_b16 a[80:81], v250 offset:0
    ds_read_b64_tr_b16 a[84:85], v251 offset:0
    ds_read_b64_tr_b16 a[88:89], v248 offset:128
    ds_read_b64_tr_b16 a[92:93], v249 offset:128
    ds_read_b64_tr_b16 a[96:97], v250 offset:128
    ds_read_b64_tr_b16 a[100:101], v251 offset:128
    ds_read_b64_tr_b16 a[104:105], v248 offset:256
    s_call_b64 s[58:59], L_STEPO
    s_waitcnt vmcnt(13)
    s_barrier
    ds_read_b64_tr_b16 a[74:75], v248 offset:18432
    ds_read_b64_tr_b16 a[78:79], v249 offset:18432
    ds_read_b64_tr_b16 a[82:83], v250 offset:18432
    ds_read_b64_tr_b16 a[86:87], v251 offset:18432
    ds_read_b64_tr_b16 a[90:91], v248 offset:18560
    ds_read_b64_tr_b16 a[94:95], v249 offset:18560
    ds_read_b64_tr_b16 a[98:99], v250 offset:18560
    ds_read_b64_tr_b16 a[102:103], v251 offset:18560
    ds_read_b64_tr_b16 a[106:107], v248 offset:18688
    s_call_b64 s[58:59], L_STEPO
    s_waitcnt vmcnt(13)
    s_barrier
    ds_read_b64_tr_b16 a[108:109], v248 offset:0
    ds_read_b64_tr_b16 a[112:113], v249 offset:0
    ds_read_b64_tr_b16 a[116:117], v250 offset:0
    ds_read_b64_tr_b16 a[120:121], v251 offset:0
    ds_read_b64_tr_b16 a[124:125], v248 offset:128
    ds_read_b64_tr_b16 a[128:129], v249 offset:128
    ds_read_b64_tr_b16 a[132:133], v250 offset:128
    ds_read_b64_tr_b16 a[136:137], v251 offset:128
    ds_read_b64_tr_b16 a[140:141], v248 offset:256
    s_call_b64 s[58:59], L_STEPO
    s_waitcnt vmcnt(13)
    s_barrier
    ds_read_b64_tr_b16 a[110:111], v248 offset:18432
    ds_read_b64_tr_b16 a[114:115], v249 offset:18432
    ds_read_b64_tr_b16 a[118:119], v250 offset:18432
    ds_read_b64_tr_b16 a[122:123], v251 offset:18432
    ds_read_b64_tr_b16 a[126:127], v248 offset:18560
    ds_read_b64_tr_b16 a[130:131], v249 offset:18560
    ds_read_b64_tr_b16 a[134:135], v250 offset:18560
    ds_read_b64_tr_b16 a[138:139], v251 offset:18560
    ds_read_b64_tr_b16 a[142:143], v248 offset:18688
    s_call_b64 s[58:59], L_STEPO
    s_waitcnt vmcnt(13)
    s_barrier
    ds_read_b64_tr_b16 a[144:145], v248 offset:0
    ds_read_b64_tr_b16 a[148:149], v249 offset:0
    ds_read_b64_tr_b16 a[152:153], v250 offset:0
    ds_read_b64_tr_b16 a[156:157], v251 offset:0
    ds_read_b64_tr_b16 a[160:161], v248 offset:128
    ds_read_b64_tr_b16 a[164:165], v249 offset:128
    ds_read_b64_tr_b16 a[168:169], v250 offset:128
    ds_read_b64_tr_b16 a[172:173], v251 offset:128
    ds_read_b64_tr_b16 a[176:177], v248 offset:256
    s_call_b64 s[58:59], L_STEPO
    s_waitcnt vmcnt(13)
    s_barrier
    ds_read_b64_tr_b16 a[146:147], v248 offset:18432
    ds_read_b64_tr_b16 a[150:151], v249 offset:18432
    ds_read_b64_tr_b16 a[154:155], v250 offset:18432
    ds_read_b64_tr_b16 a[158:159], v251 offset:18432
    ds_read_b64_tr_b16 a[162:163], v248 offset:18560
    ds_read_b64_tr_b16 a[166:167], v249 offset:18560
    ds_read_b64_tr_b16 a[170:171], v250 offset:18560
    ds_read_b64_tr_b16 a[174:175], v251 offset:18560
    ds_read_b64_tr_b16 a[178:179], v248 offset:18688
    s_call_b64 s[58:59], L_STEPO
    s_waitcnt vmcnt(13)
    s_barrier
    ds_read_b64_tr_b16 a[180:181], v248 offset:0
    ds_read_b64_tr_b16 a[184:185], v249 offset:0
    ds_read_b64_tr_b16 a[188:189], v250 offset:0
    ds_read_b64_tr_b16 a[192:193], v251 offset:0
    ds_read_b64_tr_b16 a[196:197], v248 offset:128
    ds_read_b64_tr_b16 a[200:201], v249 offset:128
    ds_read_b64_tr_b16 a[204:205], v250 offset:128
    ds_read_b64_tr_b16 a[208:209], v251 offset:128
    ds_read_b64_tr_b16 a[212:213], v248 offset:256
    s_call_b64 s[58:59], L_STEP
    s_waitcnt vmcnt(8)
    s_barrier
    ds_read_b64_tr_b16 a[182:183], v248 offset:18432
    ds_read_b64_tr_b16 a[186:187], v249 offset:18432
    ds_read_b64_tr_b16 a[190:191], v250 offset:18432
    ds_read_b64_tr_b16 a[194:195], v251 offset:18432
    ds_read_b64_tr_b16 a[198:199], v248 offset:18560
    ds_read_b64_tr_b16 a[202:203], v249 offset:18560
    ds_read_b64_tr_b16 a[206:207], v250 offset:18560
    ds_read_b64_tr_b16 a[210:211], v251 offset:18560
    ds_read_b64_tr_b16 a[214:215], v248 offset:18688
    s_call_b64 s[58:59], L_STEP
    s_call_b64 s[58:59], L_FIN
    v_and_b32 v1, 31, v0
    v_lshlrev_b32 v1, 4, v1
    v_lshrrev_b32 v3, 5, v0
    v_lshl_add_u32 v1, v3, 3, v1
    v_add_u32 v1, s97, v1
    v_cvt_pk_bf16_f32 v128, v128, v129
    v_cvt_pk_bf16_f32 v129, v130, v131
    ds_write_b64 v1, v[128:129] offset:0
    v_cvt_pk_bf16_f32 v132, v132, v133
    v_cvt_pk_bf16_f32 v133, v134, v135
    ds_write_b64 v1, v[132:133] offset:512
    v_cvt_pk_bf16_f32 v136, v136, v137
    v_cvt_pk_bf16_f32 v137, v138, v139
    ds_write_b64 v1, v[136:137] offset:1024
    v_cvt_pk_bf16_f32 v140, v140, v141
    v_cvt_pk_bf16_f32 v141, v142, v143
    ds_write_b64 v1, v[140:141] offset:1536
    v_cvt_pk_bf16_f32 v144, v144, v145
    v_cvt_pk_bf16_f32 v145, v146, v147
    ds_write_b64 v1, v[144:145] offset:2048
    v_cvt_pk_bf16_f32 v148, v148, v149
    v_cvt_pk_bf16_f32 v149, v150, v151
    ds_write_b64 v1, v[148:149] offset:2560
    v_cvt_pk_bf16_f32 v152, v152, v153
    v_cvt_pk_bf16_f32 v153, v154, v155
    ds_write_b64 v1, v[152:153] offset:3072
    v_cvt_pk_bf16_f32 v156, v156, v157
    v_cvt_pk_bf16_f32 v157, v158, v159
    ds_write_b64 v1, v[156:157] offset:3584
    v_mov_b64 v[128:129], 0
    v_mov_b64 v[130:131], 0
    v_mov_b64 v[132:133], 0
    v_mov_b64 v[134:135], 0
    v_mov_b64 v[136:137], 0
    v_mov_b64 v[138:139], 0
    v_mov_b64 v[140:141], 0
    v_mov_b64 v[142:143], 0
    v_mov_b64 v[144:145], 0
    v_mov_b64 v[146:147], 0
    v_mov_b64 v[148:149], 0
    v_mov_b64 v[150:151], 0
    v_mov_b64 v[152:153], 0
    v_mov_b64 v[154:155], 0
    v_mov_b64 v[156:157], 0
    v_mov_b64 v[158:159], 0
    v_mov_b64 v[160:161], 0
    v_mov_b64 v[162:163], 0
    v_mov_b64 v[164:165], 0
    v_mov_b64 v[166:167], 0
    v_mov_b64 v[168:169], 0
    v_mov_b64 v[170:171], 0
    v_mov_b64 v[172:173], 0
    v_mov_b64 v[174:175], 0
    v_mov_b64 v[176:177], 0
    v_mov_b64 v[178:179], 0
    v_mov_b64 v[180:181], 0
    v_mov_b64 v[182:183], 0
    v_mov_b64 v[184:185], 0
    v_mov_b64 v[186:187], 0
    v_mov_b64 v[188:189], 0
    v_mov_b64 v[190:191], 0
    v_mov_b64 v[192:193], 0
    v_mov_b64 v[194:195], 0
    v_mov_b64 v[196:197], 0
    v_mov_b64 v[198:199], 0
    s_waitcnt lgkmcnt(0)
    s_barrier
    s_and_b32 s64, s52, 1
    s_xor_b32 s64, s64, 1
    s_mul_i32 s64, s64, 18432
    s_add_u32 s64, s64, 98304
    v_lshl_add_u32 v1, v0, 4, s64
    ds_read_b128 v[200:203], v1 offset:0
    ds_read_b128 v[204:207], v1 offset:1024
    ds_read_b128 v[208:211], v1 offset:2048
    ds_read_b128 v[212:215], v1 offset:3072
    ds_read_b128 v[216:219], v1 offset:9216
    ds_read_b128 v[220:223], v1 offset:10240
    ds_read_b128 v[224:227], v1 offset:11264
    ds_read_b128 v[228:231], v1 offset:12288
    v_mov_b64 v[64:65], 0
    v_mov_b64 v[66:67], 0
    v_mov_b64 v[68:69], 0
    v_mov_b64 v[70:71], 0
    v_mov_b64 v[72:73], 0
    v_mov_b64 v[74:75], 0
    v_mov_b64 v[76:77], 0
    v_mov_b64 v[78:79], 0
    v_mov_b64 v[80:81], 0
    v_mov_b64 v[82:83], 0
    v_mov_b64 v[84:85], 0
    v_mov_b64 v[86:87], 0
    v_mov_b64 v[88:89], 0
    v_mov_b64 v[90:91], 0
    v_mov_b64 v[92:93], 0
    v_mov_b64 v[94:95], 0
    v_mov_b64 v[96:97], 0
    v_mov_b64 v[98:99], 0
    v_mov_b64 v[100:101], 0
    v_mov_b64 v[102:103], 0
    v_mov_b64 v[104:105], 0
    v_mov_b64 v[106:107], 0
    v_mov_b64 v[108:109], 0
    v_mov_b64 v[110:111], 0
    v_mov_b64 v[112:113], 0
    v_mov_b64 v[114:115], 0
    v_mov_b64 v[116:117], 0
    v_mov_b64 v[118:119], 0
    v_mov_b64 v[120:121], 0
    v_mov_b64 v[122:123], 0
    v_mov_b64 v[124:125], 0
    v_mov_b64 v[126:127], 0
    v_mov_b32 v252, 0xfe000000
    v_mov_b32 v253, 0
    s_sub_u32 s96, s96, 65536
    s_sub_u32 s97, s97, 65536
    s_waitcnt vmcnt(12)
    s_barrier
    s_call_b64 s[58:59], L_STEPO
    s_mov_b32 s64, 135168
    v_lshl_add_u32 v3, v0, 4, s64
    ds_read_b128 v[8:11], v3 offset:0
    ds_read_b128 v[12:15], v3 offset:1024
    s_waitcnt lgkmcnt(0)
    v_mfma_f32_16x16x32_bf16 v[128:131], a[0:3], v[8:11], v[128:131]
    v_mfma_f32_16x16x32_bf16 v[132:135], a[0:3], v[12:15], v[132:135]
    v_mfma_f32_16x16x32_bf16 v[136:139], a[4:7], v[8:11], v[136:139]
    v_mfma_f32_16x16x32_bf16 v[140:143], a[4:7], v[12:15], v[140:143]
    v_mfma_f32_16x16x32_bf16 v[144:147], a[8:11], v[8:11], v[144:147]
    v_mfma_f32_16x16x32_bf16 v[148:151], a[8:11], v[12:15], v[148:151]
    v_mfma_f32_16x16x32_bf16 v[152:155], a[12:15], v[8:11], v[152:155]
    v_mfma_f32_16x16x32_bf16 v[156:159], a[12:15], v[12:15], v[156:159]
    v_mfma_f32_16x16x32_bf16 v[160:163], a[16:19], v[8:11], v[160:163]
    v_mfma_f32_16x16x32_bf16 v[164:167], a[16:19], v[12:15], v[164:167]
    v_mfma_f32_16x16x32_bf16 v[168:171], a[20:23], v[8:11], v[168:171]
    v_mfma_f32_16x16x32_bf16 v[172:175], a[20:23], v[12:15], v[172:175]
    v_mfma_f32_16x16x32_bf16 v[176:179], a[24:27], v[8:11], v[176:179]
    v_mfma_f32_16x16x32_bf16 v[180:183], a[24:27], v[12:15], v[180:183]
    v_mfma_f32_16x16x32_bf16 v[184:187], a[28:31], v[8:11], v[184:187]
    v_mfma_f32_16x16x32_bf16 v[188:191], a[28:31], v[12:15], v[188:191]
    v_mfma_f32_16x16x32_bf16 v[192:195], a[32:35], v[8:11], v[192:195]
    v_mfma_f32_16x16x32_bf16 v[196:199], a[32:35], v[12:15], v[196:199]
    s_waitcnt vmcnt(17)
    s_barrier
    s_call_b64 s[58:59], L_STEPO
    s_mov_b32 s64, 135168
    v_lshl_add_u32 v3, v0, 4, s64
    ds_read_b128 v[8:11], v3 offset:2048
    ds_read_b128 v[12:15], v3 offset:3072
    s_waitcnt lgkmcnt(0)
    v_mfma_f32_16x16x32_bf16 v[128:131], a[36:39], v[8:11], v[128:131]
    v_mfma_f32_16x16x32_bf16 v[132:135], a[36:39], v[12:15], v[132:135]
    v_mfma_f32_16x16x32_bf16 v[136:139], a[40:43], v[8:11], v[136:139]
    v_mfma_f32_16x16x32_bf16 v[140:143], a[40:43], v[12:15], v[140:143]
    v_mfma_f32_16x16x32_bf16 v[144:147], a[44:47], v[8:11], v[144:147]
    v_mfma_f32_16x16x32_bf16 v[148:151], a[44:47], v[12:15], v[148:151]
    v_mfma_f32_16x16x32_bf16 v[152:155], a[48:51], v[8:11], v[152:155]
    v_mfma_f32_16x16x32_bf16 v[156:159], a[48:51], v[12:15], v[156:159]
    v_mfma_f32_16x16x32_bf16 v[160:163], a[52:55], v[8:11], v[160:163]
    v_mfma_f32_16x16x32_bf16 v[164:167], a[52:55], v[12:15], v[164:167]
    v_mfma_f32_16x16x32_bf16 v[168:171], a[56:59], v[8:11], v[168:171]
    v_mfma_f32_16x16x32_bf16 v[172:175], a[56:59], v[12:15], v[172:175]
    v_mfma_f32_16x16x32_bf16 v[176:179], a[60:63], v[8:11], v[176:179]
    v_mfma_f32_16x16x32_bf16 v[180:183], a[60:63], v[12:15], v[180:183]
    v_mfma_f32_16x16x32_bf16 v[184:187], a[64:67], v[8:11], v[184:187]
    v_mfma_f32_16x16x32_bf16 v[188:191], a[64:67], v[12:15], v[188:191]
    v_mfma_f32_16x16x32_bf16 v[192:195], a[68:71], v[8:11], v[192:195]
    v_mfma_f32_16x16x32_bf16 v[196:199], a[68:71], v[12:15], v[196:199]
    s_waitcnt vmcnt(13)
    s_barrier
    ds_read_b64_tr_b16 a[216:217], v248 offset:0
    ds_read_b64_tr_b16 a[220:221], v249 offset:0
    ds_read_b64_tr_b16 a[224:225], v250 offset:0
    ds_read_b64_tr_b16 a[228:229], v251 offset:0
    ds_read_b64_tr_b16 a[232:233], v248 offset:128
    ds_read_b64_tr_b16 a[236:237], v249 offset:128
    ds_read_b64_tr_b16 a[240:241], v250 offset:128
    ds_read_b64_tr_b16 a[244:245], v251 offset:128
    ds_read_b64_tr_b16 a[248:249], v248 offset:256
    s_call_b64 s[58:59], L_STEPO
    s_mov_b32 s64, 135168
    v_lshl_add_u32 v3, v0, 4, s64
    ds_read_b128 v[8:11], v3 offset:8192
    ds_read_b128 v[12:15], v3 offset:9216
    s_waitcnt lgkmcnt(0)
    v_mfma_f32_16x16x32_bf16 v[128:131], a[72:75], v[8:11], v[128:131]
    v_mfma_f32_16x16x32_bf16 v[132:135], a[72:75], v[12:15], v[132:135]
    v_mfma_f32_16x16x32_bf16 v[136:139], a[76:79], v[8:11], v[136:139]
    v_mfma_f32_16x16x32_bf16 v[140:143], a[76:79], v[12:15], v[140:143]
    v_mfma_f32_16x16x32_bf16 v[144:147], a[80:83], v[8:11], v[144:147]
    v_mfma_f32_16x16x32_bf16 v[148:151], a[80:83], v[12:15], v[148:151]
    v_mfma_f32_16x16x32_bf16 v[152:155], a[84:87], v[8:11], v[152:155]
    v_mfma_f32_16x16x32_bf16 v[156:159], a[84:87], v[12:15], v[156:159]
    v_mfma_f32_16x16x32_bf16 v[160:163], a[88:91], v[8:11], v[160:163]
    v_mfma_f32_16x16x32_bf16 v[164:167], a[88:91], v[12:15], v[164:167]
    v_mfma_f32_16x16x32_bf16 v[168:171], a[92:95], v[8:11], v[168:171]
    v_mfma_f32_16x16x32_bf16 v[172:175], a[92:95], v[12:15], v[172:175]
    v_mfma_f32_16x16x32_bf16 v[176:179], a[96:99], v[8:11], v[176:179]
    v_mfma_f32_16x16x32_bf16 v[180:183], a[96:99], v[12:15], v[180:183]
    v_mfma_f32_16x16x32_bf16 v[184:187], a[100:103], v[8:11], v[184:187]
    v_mfma_f32_16x16x32_bf16 v[188:191], a[100:103], v[12:15], v[188:191]
    v_mfma_f32_16x16x32_bf16 v[192:195], a[104:107], v[8:11], v[192:195]
    v_mfma_f32_16x16x32_bf16 v[196:199], a[104:107], v[12:15], v[196:199]
    s_waitcnt vmcnt(13)
    s_barrier
    ds_read_b64_tr_b16 a[218:219], v248 offset:18432
    ds_read_b64_tr_b16 a[222:223], v249 offset:18432
    ds_read_b64_tr_b16 a[226:227], v250 offset:18432
    ds_read_b64_tr_b16 a[230:231], v251 offset:18432
    ds_read_b64_tr_b16 a[234:235], v248 offset:18560
    ds_read_b64_tr_b16 a[238:239], v249 offset:18560
    ds_read_b64_tr_b16 a[242:243], v250 offset:18560
    ds_read_b64_tr_b16 a[246:247], v251 offset:18560
    ds_read_b64_tr_b16 a[250:251], v248 offset:18688
    s_call_b64 s[58:59], L_STEPO
    s_mov_b32 s64, 135168
    v_lshl_add_u32 v3, v0, 4, s64
    ds_read_b128 v[8:11], v3 offset:10240
    ds_read_b128 v[12:15], v3 offset:11264
    s_waitcnt lgkmcnt(0)
    v_mfma_f32_16x16x32_bf16 v[128:131], a[108:111], v[8:11], v[128:131]
    v_mfma_f32_16x16x32_bf16 v[132:135], a[108:111], v[12:15], v[132:135]
    v_mfma_f32_16x16x32_bf16 v[136:139], a[112:115], v[8:11], v[136:139]
    v_mfma_f32_16x16x32_bf16 v[140:143], a[112:115], v[12:15], v[140:143]
    v_mfma_f32_16x16x32_bf16 v[144:147], a[116:119], v[8:11], v[144:147]
    v_mfma_f32_16x16x32_bf16 v[148:151], a[116:119], v[12:15], v[148:151]
    v_mfma_f32_16x16x32_bf16 v[152:155], a[120:123], v[8:11], v[152:155]
    v_mfma_f32_16x16x32_bf16 v[156:159], a[120:123], v[12:15], v[156:159]
    v_mfma_f32_16x16x32_bf16 v[160:163], a[124:127], v[8:11], v[160:163]
    v_mfma_f32_16x16x32_bf16 v[164:167], a[124:127], v[12:15], v[164:167]
    v_mfma_f32_16x16x32_bf16 v[168:171], a[128:131], v[8:11], v[168:171]
    v_mfma_f32_16x16x32_bf16 v[172:175], a[128:131], v[12:15], v[172:175]
    v_mfma_f32_16x16x32_bf16 v[176:179], a[132:135], v[8:11], v[176:179]
    v_mfma_f32_16x16x32_bf16 v[180:183], a[132:135], v[12:15], v[180:183]
    v_mfma_f32_16x16x32_bf16 v[184:187], a[136:139], v[8:11], v[184:187]
    v_mfma_f32_16x16x32_bf16 v[188:191], a[136:139], v[12:15], v[188:191]
    v_mfma_f32_16x16x32_bf16 v[192:195], a[140:143], v[8:11], v[192:195]
    v_mfma_f32_16x16x32_bf16 v[196:199], a[140:143], v[12:15], v[196:199]
    s_waitcnt vmcnt(13)
    s_barrier
    ds_read_b64_tr_b16 a[0:1], v248 offset:0
    ds_read_b64_tr_b16 a[4:5], v249 offset:0
    ds_read_b64_tr_b16 a[8:9], v250 offset:0
    ds_read_b64_tr_b16 a[12:13], v251 offset:0
    ds_read_b64_tr_b16 a[16:17], v248 offset:128
    ds_read_b64_tr_b16 a[20:21], v249 offset:128
    ds_read_b64_tr_b16 a[24:25], v250 offset:128
    ds_read_b64_tr_b16 a[28:29], v251 offset:128
    ds_read_b64_tr_b16 a[32:33], v248 offset:256
    s_call_b64 s[58:59], L_STEPO
    s_mov_b32 s64, 135168
    v_lshl_add_u32 v3, v0, 4, s64
    ds_read_b128 v[8:11], v3 offset:4096
    ds_read_b128 v[12:15], v3 offset:5120
    s_waitcnt lgkmcnt(0)
    v_mfma_f32_16x16x32_bf16 v[128:131], a[144:147], v[8:11], v[128:131]
    v_mfma_f32_16x16x32_bf16 v[132:135], a[144:147], v[12:15], v[132:135]
    v_mfma_f32_16x16x32_bf16 v[136:139], a[148:151], v[8:11], v[136:139]
    v_mfma_f32_16x16x32_bf16 v[140:143], a[148:151], v[12:15], v[140:143]
    v_mfma_f32_16x16x32_bf16 v[144:147], a[152:155], v[8:11], v[144:147]
    v_mfma_f32_16x16x32_bf16 v[148:151], a[152:155], v[12:15], v[148:151]
    v_mfma_f32_16x16x32_bf16 v[152:155], a[156:159], v[8:11], v[152:155]
    v_mfma_f32_16x16x32_bf16 v[156:159], a[156:159], v[12:15], v[156:159]
    v_mfma_f32_16x16x32_bf16 v[160:163], a[160:163], v[8:11], v[160:163]
    v_mfma_f32_16x16x32_bf16 v[164:167], a[160:163], v[12:15], v[164:167]
    v_mfma_f32_16x16x32_bf16 v[168:171], a[164:167], v[8:11], v[168:171]
    v_mfma_f32_16x16x32_bf16 v[172:175], a[164:167], v[12:15], v[172:175]
    v_mfma_f32_16x16x32_bf16 v[176:179], a[168:171], v[8:11], v[176:179]
    v_mfma_f32_16x16x32_bf16 v[180:183], a[168:171], v[12:15], v[180:183]
    v_mfma_f32_16x16x32_bf16 v[184:187], a[172:175], v[8:11], v[184:187]
    v_mfma_f32_16x16x32_bf16 v[188:191], a[172:175], v[12:15], v[188:191]
    v_mfma_f32_16x16x32_bf16 v[192:195], a[176:179], v[8:11], v[192:195]
    v_mfma_f32_16x16x32_bf16 v[196:199], a[176:179], v[12:15], v[196:199]
    s_waitcnt vmcnt(13)
    s_barrier
    ds_read_b64_tr_b16 a[2:3], v248 offset:18432
    ds_read_b64_tr_b16 a[6:7], v249 offset:18432
    ds_read_b64_tr_b16 a[10:11], v250 offset:18432
    ds_read_b64_tr_b16 a[14:15], v251 offset:18432
    ds_read_b64_tr_b16 a[18:19], v248 offset:18560
    ds_read_b64_tr_b16 a[22:23], v249 offset:18560
    ds_read_b64_tr_b16 a[26:27], v250 offset:18560
    ds_read_b64_tr_b16 a[30:31], v251 offset:18560
    ds_read_b64_tr_b16 a[34:35], v248 offset:18688
    s_call_b64 s[58:59], L_STEPO
    s_mov_b32 s64, 135168
    v_lshl_add_u32 v3, v0, 4, s64
    ds_read_b128 v[8:11], v3 offset:6144
    ds_read_b128 v[12:15], v3 offset:7168
    s_waitcnt lgkmcnt(0)
    v_mfma_f32_16x16x32_bf16 v[128:131], a[180:183], v[8:11], v[128:131]
    v_mfma_f32_16x16x32_bf16 v[132:135], a[180:183], v[12:15], v[132:135]
    v_mfma_f32_16x16x32_bf16 v[136:139], a[184:187], v[8:11], v[136:139]
    v_mfma_f32_16x16x32_bf16 v[140:143], a[184:187], v[12:15], v[140:143]
    v_mfma_f32_16x16x32_bf16 v[144:147], a[188:191], v[8:11], v[144:147]
    v_mfma_f32_16x16x32_bf16 v[148:151], a[188:191], v[12:15], v[148:151]
    v_mfma_f32_16x16x32_bf16 v[152:155], a[192:195], v[8:11], v[152:155]
    v_mfma_f32_16x16x32_bf16 v[156:159], a[192:195], v[12:15], v[156:159]
    v_mfma_f32_16x16x32_bf16 v[160:163], a[196:199], v[8:11], v[160:163]
    v_mfma_f32_16x16x32_bf16 v[164:167], a[196:199], v[12:15], v[164:167]
    v_mfma_f32_16x16x32_bf16 v[168:171], a[200:203], v[8:11], v[168:171]
    v_mfma_f32_16x16x32_bf16 v[172:175], a[200:203], v[12:15], v[172:175]
    v_mfma_f32_16x16x32_bf16 v[176:179], a[204:207], v[8:11], v[176:179]
    v_mfma_f32_16x16x32_bf16 v[180:183], a[204:207], v[12:15], v[180:183]
    v_mfma_f32_16x16x32_bf16 v[184:187], a[208:211], v[8:11], v[184:187]
    v_mfma_f32_16x16x32_bf16 v[188:191], a[208:211], v[12:15], v[188:191]
    v_mfma_f32_16x16x32_bf16 v[192:195], a[212:215], v[8:11], v[192:195]
    v_mfma_f32_16x16x32_bf16 v[196:199], a[212:215], v[12:15], v[196:199]
    s_waitcnt vmcnt(13)
    s_barrier
    ds_read_b64_tr_b16 a[36:37], v248 offset:0
    ds_read_b64_tr_b16 a[40:41], v249 offset:0
    ds_read_b64_tr_b16 a[44:45], v250 offset:0
    ds_read_b64_tr_b16 a[48:49], v251 offset:0
    ds_read_b64_tr_b16 a[52:53], v248 offset:128
    ds_read_b64_tr_b16 a[56:57], v249 offset:128
    ds_read_b64_tr_b16 a[60:61], v250 offset:128
    ds_read_b64_tr_b16 a[64:65], v251 offset:128
    ds_read_b64_tr_b16 a[68:69], v248 offset:256
    s_call_b64 s[58:59], L_STEPO
    s_mov_b32 s64, 135168
    v_lshl_add_u32 v3, v0, 4, s64
    ds_read_b128 v[8:11], v3 offset:12288
    ds_read_b128 v[12:15], v3 offset:13312
    s_waitcnt lgkmcnt(0)
    v_mfma_f32_16x16x32_bf16 v[128:131], a[216:219], v[8:11], v[128:131]
    v_mfma_f32_16x16x32_bf16 v[132:135], a[216:219], v[12:15], v[132:135]
    v_mfma_f32_16x16x32_bf16 v[136:139], a[220:223], v[8:11], v[136:139]
    v_mfma_f32_16x16x32_bf16 v[140:143], a[220:223], v[12:15], v[140:143]
    v_mfma_f32_16x16x32_bf16 v[144:147], a[224:227], v[8:11], v[144:147]
    v_mfma_f32_16x16x32_bf16 v[148:151], a[224:227], v[12:15], v[148:151]
    v_mfma_f32_16x16x32_bf16 v[152:155], a[228:231], v[8:11], v[152:155]
    v_mfma_f32_16x16x32_bf16 v[156:159], a[228:231], v[12:15], v[156:159]
    v_mfma_f32_16x16x32_bf16 v[160:163], a[232:235], v[8:11], v[160:163]
    v_mfma_f32_16x16x32_bf16 v[164:167], a[232:235], v[12:15], v[164:167]
    v_mfma_f32_16x16x32_bf16 v[168:171], a[236:239], v[8:11], v[168:171]
    v_mfma_f32_16x16x32_bf16 v[172:175], a[236:239], v[12:15], v[172:175]
    v_mfma_f32_16x16x32_bf16 v[176:179], a[240:243], v[8:11], v[176:179]
    v_mfma_f32_16x16x32_bf16 v[180:183], a[240:243], v[12:15], v[180:183]
    v_mfma_f32_16x16x32_bf16 v[184:187], a[244:247], v[8:11], v[184:187]
    v_mfma_f32_16x16x32_bf16 v[188:191], a[244:247], v[12:15], v[188:191]
    v_mfma_f32_16x16x32_bf16 v[192:195], a[248:251], v[8:11], v[192:195]
    v_mfma_f32_16x16x32_bf16 v[196:199], a[248:251], v[12:15], v[196:199]
    s_waitcnt vmcnt(13)
    s_barrier
    ds_read_b64_tr_b16 a[38:39], v248 offset:18432
    ds_read_b64_tr_b16 a[42:43], v249 offset:18432
    ds_read_b64_tr_b16 a[46:47], v250 offset:18432
    ds_read_b64_tr_b16 a[50:51], v251 offset:18432
    ds_read_b64_tr_b16 a[54:55], v248 offset:18560
    ds_read_b64_tr_b16 a[58:59], v249 offset:18560
    ds_read_b64_tr_b16 a[62:63], v250 offset:18560
    ds_read_b64_tr_b16 a[66:67], v251 offset:18560
    ds_read_b64_tr_b16 a[70:71], v248 offset:18688
    s_call_b64 s[58:59], L_STEPO
    s_mov_b32 s64, 135168
    v_lshl_add_u32 v3, v0, 4, s64
    ds_read_b128 v[8:11], v3 offset:14336
    ds_read_b128 v[12:15], v3 offset:15360
    s_waitcnt lgkmcnt(0)
    v_mfma_f32_16x16x32_bf16 v[128:131], a[0:3], v[8:11], v[128:131]
    v_mfma_f32_16x16x32_bf16 v[132:135], a[0:3], v[12:15], v[132:135]
    v_mfma_f32_16x16x32_bf16 v[136:139], a[4:7], v[8:11], v[136:139]
    v_mfma_f32_16x16x32_bf16 v[140:143], a[4:7], v[12:15], v[140:143]
    v_mfma_f32_16x16x32_bf16 v[144:147], a[8:11], v[8:11], v[144:147]
    v_mfma_f32_16x16x32_bf16 v[148:151], a[8:11], v[12:15], v[148:151]
    v_mfma_f32_16x16x32_bf16 v[152:155], a[12:15], v[8:11], v[152:155]
    v_mfma_f32_16x16x32_bf16 v[156:159], a[12:15], v[12:15], v[156:159]
    v_mfma_f32_16x16x32_bf16 v[160:163], a[16:19], v[8:11], v[160:163]
    v_mfma_f32_16x16x32_bf16 v[164:167], a[16:19], v[12:15], v[164:167]
    v_mfma_f32_16x16x32_bf16 v[168:171], a[20:23], v[8:11], v[168:171]
    v_mfma_f32_16x16x32_bf16 v[172:175], a[20:23], v[12:15], v[172:175]
    v_mfma_f32_16x16x32_bf16 v[176:179], a[24:27], v[8:11], v[176:179]
    v_mfma_f32_16x16x32_bf16 v[180:183], a[24:27], v[12:15], v[180:183]
    v_mfma_f32_16x16x32_bf16 v[184:187], a[28:31], v[8:11], v[184:187]
    v_mfma_f32_16x16x32_bf16 v[188:191], a[28:31], v[12:15], v[188:191]
    v_mfma_f32_16x16x32_bf16 v[192:195], a[32:35], v[8:11], v[192:195]
    v_mfma_f32_16x16x32_bf16 v[196:199], a[32:35], v[12:15], v[196:199]
    s_waitcnt vmcnt(13)
    s_barrier
    ds_read_b64_tr_b16 a[72:73], v248 offset:0
    ds_read_b64_tr_b16 a[76:77], v249 offset:0
    ds_read_b64_tr_b16 a[80:81], v250 offset:0
    ds_read_b64_tr_b16 a[84:85], v251 offset:0
    ds_read_b64_tr_b16 a[88:89], v248 offset:128
    ds_read_b64_tr_b16 a[92:93], v249 offset:128
    ds_read_b64_tr_b16 a[96:97], v250 offset:128
    ds_read_b64_tr_b16 a[100:101], v251 offset:128
    ds_read_b64_tr_b16 a[104:105], v248 offset:256
    s_call_b64 s[58:59], L_STEPO
    s_waitcnt vmcnt(13)
    s_barrier
    ds_read_b64_tr_b16 a[74:75], v248 offset:18432
    ds_read_b64_tr_b16 a[78:79], v249 offset:18432
    ds_read_b64_tr_b16 a[82:83], v250 offset:18432
    ds_read_b64_tr_b16 a[86:87], v251 offset:18432
    ds_read_b64_tr_b16 a[90:91], v248 offset:18560
    ds_read_b64_tr_b16 a[94:95], v249 offset:18560
    ds_read_b64_tr_b16 a[98:99], v250 offset:18560
    ds_read_b64_tr_b16 a[102:103], v251 offset:18560
    ds_read_b64_tr_b16 a[106:107], v248 offset:18688
    s_call_b64 s[58:59], L_STEPO
    s_waitcnt vmcnt(13)
    s_barrier
    ds_read_b64_tr_b16 a[108:109], v248 offset:0
    ds_read_b64_tr_b16 a[112:113], v249 offset:0
    ds_read_b64_tr_b16 a[116:117], v250 offset:0
    ds_read_b64_tr_b16 a[120:121], v251 offset:0
    ds_read_b64_tr_b16 a[124:125], v248 offset:128
    ds_read_b64_tr_b16 a[128:129], v249 offset:128
    ds_read_b64_tr_b16 a[132:133], v250 offset:128
    ds_read_b64_tr_b16 a[136:137], v251 offset:128
    ds_read_b64_tr_b16 a[140:141], v248 offset:256
    s_call_b64 s[58:59], L_STEPO
    s_waitcnt vmcnt(13)
    s_barrier
    ds_read_b64_tr_b16 a[110:111], v248 offset:18432
    ds_read_b64_tr_b16 a[114:115], v249 offset:18432
    ds_read_b64_tr_b16 a[118:119], v250 offset:18432
    ds_read_b64_tr_b16 a[122:123], v251 offset:18432
    ds_read_b64_tr_b16 a[126:127], v248 offset:18560
    ds_read_b64_tr_b16 a[130:131], v249 offset:18560
    ds_read_b64_tr_b16 a[134:135], v250 offset:18560
    ds_read_b64_tr_b16 a[138:139], v251 offset:18560
    ds_read_b64_tr_b16 a[142:143], v248 offset:18688
    s_call_b64 s[58:59], L_STEPO
    s_waitcnt vmcnt(13)
    s_barrier
    ds_read_b64_tr_b16 a[144:145], v248 offset:0
    ds_read_b64_tr_b16 a[148:149], v249 offset:0
    ds_read_b64_tr_b16 a[152:153], v250 offset:0
    ds_read_b64_tr_b16 a[156:157], v251 offset:0
    ds_read_b64_tr_b16 a[160:161], v248 offset:128
    ds_read_b64_tr_b16 a[164:165], v249 offset:128
    ds_read_b64_tr_b16 a[168:169], v250 offset:128
    ds_read_b64_tr_b16 a[172:173], v251 offset:128
    ds_read_b64_tr_b16 a[176:177], v248 offset:256
    s_call_b64 s[58:59], L_STEPO
    s_waitcnt vmcnt(13)
    s_barrier
    ds_read_b64_tr_b16 a[146:147], v248 offset:18432
    ds_read_b64_tr_b16 a[150:151], v249 offset:18432
    ds_read_b64_tr_b16 a[154:155], v250 offset:18432
    ds_read_b64_tr_b16 a[158:159], v251 offset:18432
    ds_read_b64_tr_b16 a[162:163], v248 offset:18560
    ds_read_b64_tr_b16 a[166:167], v249 offset:18560
    ds_read_b64_tr_b16 a[170:171], v250 offset:18560
    ds_read_b64_tr_b16 a[174:175], v251 offset:18560
    ds_read_b64_tr_b16 a[178:179], v248 offset:18688
    s_call_b64 s[58:59], L_STEPO
    s_waitcnt vmcnt(13)
    s_barrier
    ds_read_b64_tr_b16 a[180:181], v248 offset:0
    ds_read_b64_tr_b16 a[184:185], v249 offset:0
    ds_read_b64_tr_b16 a[188:189], v250 offset:0
    ds_read_b64_tr_b16 a[192:193], v251 offset:0
    ds_read_b64_tr_b16 a[196:197], v248 offset:128
    ds_read_b64_tr_b16 a[200:201], v249 offset:128
    ds_read_b64_tr_b16 a[204:205], v250 offset:128
    ds_read_b64_tr_b16 a[208:209], v251 offset:128
    ds_read_b64_tr_b16 a[212:213], v248 offset:256
    s_call_b64 s[58:59], L_STEPO
    s_waitcnt vmcnt(13)
    s_barrier
    ds_read_b64_tr_b16 a[182:183], v248 offset:18432
    ds_read_b64_tr_b16 a[186:187], v249 offset:18432
    ds_read_b64_tr_b16 a[190:191], v250 offset:18432
    ds_read_b64_tr_b16 a[194:195], v251 offset:18432
    ds_read_b64_tr_b16 a[198:199], v248 offset:18560
    ds_read_b64_tr_b16 a[202:203], v249 offset:18560
    ds_read_b64_tr_b16 a[206:207], v250 offset:18560
    ds_read_b64_tr_b16 a[210:211], v251 offset:18560
    ds_read_b64_tr_b16 a[214:215], v248 offset:18688
    s_call_b64 s[58:59], L_STEPO
    s_waitcnt vmcnt(13)
    s_barrier
    ds_read_b64_tr_b16 a[216:217], v248 offset:0
    ds_read_b64_tr_b16 a[220:221], v249 offset:0
    ds_read_b64_tr_b16 a[224:225], v250 offset:0
    ds_read_b64_tr_b16 a[228:229], v251 offset:0
    ds_read_b64_tr_b16 a[232:233], v248 offset:128
    ds_read_b64_tr_b16 a[236:237], v249 offset:128
    ds_read_b64_tr_b16 a[240:241], v250 offset:128
    ds_read_b64_tr_b16 a[244:245], v251 offset:128
    ds_read_b64_tr_b16 a[248:249], v248 offset:256
    s_call_b64 s[58:59], L_STEPO
    s_waitcnt vmcnt(13)
    s_barrier
    ds_read_b64_tr_b16 a[218:219], v248 offset:18432
    ds_read_b64_tr_b16 a[222:223], v249 offset:18432
    ds_read_b64_tr_b16 a[226:227], v250 offset:18432
    ds_read_b64_tr_b16 a[230:231], v251 offset:18432
    ds_read_b64_tr_b16 a[234:235], v248 offset:18560
    ds_read_b64_tr_b16 a[238:239], v249 offset:18560
    ds_read_b64_tr_b16 a[242:243], v250 offset:18560
    ds_read_b64_tr_b16 a[246:247], v251 offset:18560
    ds_read_b64_tr_b16 a[250:251], v248 offset:18688
    s_call_b64 s[58:59], L_STEPO
    s_waitcnt vmcnt(13)
    s_barrier
    ds_read_b64_tr_b16 a[0:1], v248 offset:0
    ds_read_b64_tr_b16 a[4:5], v249 offset:0
    ds_read_b64_tr_b16 a[8:9], v250 offset:0
    ds_read_b64_tr_b16 a[12:13], v251 offset:0
    ds_read_b64_tr_b16 a[16:17], v248 offset:128
    ds_read_b64_tr_b16 a[20:21], v249 offset:128
    ds_read_b64_tr_b16 a[24:25], v250 offset:128
    ds_read_b64_tr_b16 a[28:29], v251 offset:128
    ds_read_b64_tr_b16 a[32:33], v248 offset:256
    s_call_b64 s[58:59], L_STEPO
    s_mov_b64 exec, 1
    buffer_load_dwordx2 v[244:245], v246, s[44:47], 0 offen sc1
    s_mov_b64 exec, -1
    s_waitcnt vmcnt(14)
    s_barrier
    ds_read_b64_tr_b16 a[2:3], v248 offset:18432
    ds_read_b64_tr_b16 a[6:7], v249 offset:18432
    ds_read_b64_tr_b16 a[10:11], v250 offset:18432
    ds_read_b64_tr_b16 a[14:15], v251 offset:18432
    ds_read_b64_tr_b16 a[18:19], v248 offset:18560
    ds_read_b64_tr_b16 a[22:23], v249 offset:18560
    ds_read_b64_tr_b16 a[26:27], v250 offset:18560
    ds_read_b64_tr_b16 a[30:31], v251 offset:18560
    ds_read_b64_tr_b16 a[34:35], v248 offset:18688
    s_call_b64 s[58:59], L_STEPO
    s_waitcnt vmcnt(23)
    s_barrier
    s_call_b64 s[58:59], L_STEP
    s_waitcnt vmcnt(17)
    s_barrier
    v_add_u32 v255, s57, v241
    ds_read_b128 v[32:35], v255
    v_xor_b32 v3, 64, v255
    ds_read_b128 v[40:43], v3
    v_xor_b32 v3, 128, v255
    ds_read_b128 v[48:51], v3
    v_xor_b32 v3, 192, v255
    ds_read_b128 v[56:59], v3
    v_xor_b32 v3, 32, v255
    ds_read_b128 v[36:39], v3
    v_xor_b32 v3, 96, v255
    ds_read_b128 v[44:47], v3
    v_xor_b32 v3, 160, v255
    ds_read_b128 v[52:55], v3
    v_xor_b32 v3, 224, v255
    ds_read_b128 v[60:63], v3
    s_call_b64 s[58:59], L_A
    s_waitcnt vmcnt(8) lgkmcnt(0)
    s_barrier
    s_call_b64 s[58:59], L_B
    s_call_b64 s[58:59], L_A
    s_waitcnt vmcnt(8) lgkmcnt(0)
    s_barrier
    s_call_b64 s[58:59], L_B
    s_waitcnt vmcnt(37)
    v_readfirstlane_b32 s68, v244
    v_readfirstlane_b32 s69, v245
    s_mov_b32 s66, 0x400000
    s_cmp_lg_u32 s52, 0
    s_cbranch_scc1 L_NOK
L_NCHK:
    s_cmp_lg_u32 s68, 0
    s_cbranch_scc1 L_NOK
    s_mov_b64 exec, 1
    buffer_load_dwordx2 v[244:245], v246, s[44:47], 0 offen sc1
    s_mov_b64 exec, -1
    s_waitcnt vmcnt(0)
    v_readfirstlane_b32 s68, v244
    v_readfirstlane_b32 s69, v245
    s_sleep 2
    s_sub_u32 s66, s66, 1
    s_cmp_lg_u32 s66, 0
    s_cbranch_scc1 L_NCHK
L_NOK:
    v_mov_b32 v244, s68
    v_mov_b32 v245, s69
    s_call_b64 s[58:59], L_A
    s_waitcnt vmcnt(8) lgkmcnt(0)
    s_barrier
    s_call_b64 s[58:59], L_B
    s_call_b64 s[58:59], L_A
    s_waitcnt vmcnt(8) lgkmcnt(0)
    s_barrier
    s_call_b64 s[58:59], L_B
    s_call_b64 s[58:59], L_A
    s_waitcnt vmcnt(8) lgkmcnt(0)
    s_barrier
    s_call_b64 s[58:59], L_B
    s_call_b64 s[58:59], L_A
    s_waitcnt vmcnt(8) lgkmcnt(0)
    s_barrier
    s_call_b64 s[58:59], L_B
    s_call_b64 s[58:59], L_A
    s_waitcnt vmcnt(8) lgkmcnt(0)
    s_barrier
    s_call_b64 s[58:59], L_B
    s_call_b64 s[58:59], L_A
    s_waitcnt vmcnt(8) lgkmcnt(0)
    s_barrier
    s_call_b64 s[58:59], L_B
    s_call_b64 s[58:59], L_A
    s_waitcnt vmcnt(8) lgkmcnt(0)
    s_barrier
    s_call_b64 s[58:59], L_B_N
    v_mov_b32 v247, 1
    s_mov_b64 exec, 1
    buffer_atomic_add v247, v246, s[44:47], 0 offen offset:128 sc0
    s_mov_b64 exec, -1
    s_call_b64 s[58:59], L_A_NV
    s_waitcnt vmcnt(5) lgkmcnt(0)
    s_barrier
    s_call_b64 s[58:59], L_B_N
    s_call_b64 s[58:59], L_LAST1
    s_waitcnt vmcnt(1)
    s_barrier
    s_call_b64 s[58:59], L_LAST2
    s_waitcnt vmcnt(63)
    ds_read_b64_tr_b16 v[32:33], v248 offset:0
    ds_read_b64_tr_b16 v[34:35], v248 offset:18432
    ds_read_b64_tr_b16 v[36:37], v249 offset:0
    ds_read_b64_tr_b16 v[38:39], v249 offset:18432
    ds_read_b64_tr_b16 v[40:41], v250 offset:0
    ds_read_b64_tr_b16 v[42:43], v250 offset:18432
    ds_read_b64_tr_b16 v[44:45], v251 offset:0
    ds_read_b64_tr_b16 v[46:47], v251 offset:18432
    ds_read_b64_tr_b16 v[48:49], v248 offset:128
    ds_read_b64_tr_b16 v[50:51], v248 offset:18560
    ds_read_b64_tr_b16 v[52:53], v249 offset:128
    ds_read_b64_tr_b16 v[54:55], v249 offset:18560
    ds_read_b64_tr_b16 v[56:57], v250 offset:128
    ds_read_b64_tr_b16 v[58:59], v250 offset:18560
    s_waitcnt lgkmcnt(4)
    ds_read_b64_tr_b16 v[60:61], v251 offset:128
    ds_read_b64_tr_b16 v[62:63], v251 offset:18560
    ds_read_b64_tr_b16 v[200:201], v248 offset:256
    ds_read_b64_tr_b16 v[202:203], v248 offset:18688
    s_call_b64 s[58:59], L_FIN
    s_lshl_b32 s67, s53, 7
    s_add_u32 s67, s67, 33554432
    s_lshl_b32 s64, s52, 2
    s_add_u32 s64, s64, 151552
    v_mov_b32 v3, s64
    s_waitcnt vmcnt(0)
    v_readfirstlane_b32 s65, v247
    s_mov_b64 exec, 1
    ds_write_b32 v3, v247
    s_mov_b64 exec, -1
    s_cmp_lg_u32 s65, 200
    s_cbranch_scc1 L_NOGO
    v_lshlrev_b32 v3, 7, v0
    s_mov_b32 s64, 33554496
    s_mov_b64 exec, 0xffffffff
    buffer_store_dwordx2 v[244:245], v3, s[48:51], s64 offen sc1
    s_mov_b64 exec, -1
L_NOGO:
    s_mov_b32 s64, 135168
    v_lshl_add_u32 v3, v0, 4, s64
    v_lshlrev_b32 v1, 4, v0
    v_mov_b32 v2, 151552
    s_mul_i32 s64, s2, 36864
    s_mul_i32 s65, s52, 9216
    s_add_u32 s76, s64, s65
    s_waitcnt lgkmcnt(0)
    s_barrier
    ds_read_b32 v247, v2
    ds_read_b128 v[64:67], v3 offset:0
    ds_read_b128 v[68:71], v3 offset:1024
    ds_read_b128 v[72:75], v3 offset:2048
    ds_read_b128 v[76:79], v3 offset:3072
    ds_read_b128 v[80:83], v3 offset:8192
    ds_read_b128 v[84:87], v3 offset:9216
    ds_read_b128 v[88:91], v3 offset:10240
    ds_read_b128 v[92:95], v3 offset:11264
    ds_read_b128 v[96:99], v3 offset:4096
    ds_read_b128 v[100:103], v3 offset:5120
    ds_read_b128 v[104:107], v3 offset:6144
    ds_read_b128 v[108:111], v3 offset:7168
    s_waitcnt lgkmcnt(10)
    v_mfma_f32_16x16x32_bf16 v[128:131], a[36:39], v[64:67], v[128:131]
    v_mfma_f32_16x16x32_bf16 v[132:135], a[36:39], v[68:71], v[132:135]
    ds_read_b128 v[112:115], v3 offset:12288
    ds_read_b128 v[116:119], v3 offset:13312
    ds_read_b128 v[120:123], v3 offset:14336
    ds_read_b128 v[124:127], v3 offset:15360
    s_waitcnt lgkmcnt(12)
    v_mfma_f32_16x16x32_bf16 v[128:131], a[72:75], v[72:75], v[128:131]
    v_mfma_f32_16x16x32_bf16 v[132:135], a[72:75], v[76:79], v[132:135]
    s_waitcnt lgkmcnt(10)
    v_mfma_f32_16x16x32_bf16 v[128:131], a[108:111], v[80:83], v[128:131]
    v_mfma_f32_16x16x32_bf16 v[132:135], a[108:111], v[84:87], v[132:135]
    v_readfirstlane_b32 s98, v247
    s_nop 0
    s_cmp_ge_u32 s98, 180
    s_cselect_b32 s64, s76, 0x10000000
    s_cselect_b32 s98, 1, 0
    s_waitcnt lgkmcnt(8)
    v_mfma_f32_16x16x32_bf16 v[128:131], a[144:147], v[88:91], v[128:131]
    v_mfma_f32_16x16x32_bf16 v[132:135], a[144:147], v[92:95], v[132:135]
    s_waitcnt lgkmcnt(6)
    v_mfma_f32_16x16x32_bf16 v[128:131], a[180:183], v[96:99], v[128:131]
    v_mfma_f32_16x16x32_bf16 v[132:135], a[180:183], v[100:103], v[132:135]
    s_waitcnt lgkmcnt(4)
    v_mfma_f32_16x16x32_bf16 v[128:131], a[216:219], v[104:107], v[128:131]
    v_mfma_f32_16x16x32_bf16 v[132:135], a[216:219], v[108:111], v[132:135]
    s_waitcnt lgkmcnt(2)
    v_mfma_f32_16x16x32_bf16 v[128:131], a[0:3], v[112:115], v[128:131]
    v_mfma_f32_16x16x32_bf16 v[132:135], a[0:3], v[116:119], v[132:135]
    s_waitcnt lgkmcnt(0)
    v_mfma_f32_16x16x32_bf16 v[128:131], v[32:35], v[120:123], v[128:131]
    v_mfma_f32_16x16x32_bf16 v[132:135], v[32:35], v[124:127], v[132:135]
    v_mfma_f32_16x16x32_bf16 v[136:139], a[40:43], v[64:67], v[136:139]
    v_mfma_f32_16x16x32_bf16 v[140:143], a[40:43], v[68:71], v[140:143]
    v_mfma_f32_16x16x32_bf16 v[136:139], a[76:79], v[72:75], v[136:139]
    v_mfma_f32_16x16x32_bf16 v[140:143], a[76:79], v[76:79], v[140:143]
    v_mfma_f32_16x16x32_bf16 v[136:139], a[112:115], v[80:83], v[136:139]
    v_mfma_f32_16x16x32_bf16 v[140:143], a[112:115], v[84:87], v[140:143]
    v_mfma_f32_16x16x32_bf16 v[136:139], a[148:151], v[88:91], v[136:139]
    v_mfma_f32_16x16x32_bf16 v[140:143], a[148:151], v[92:95], v[140:143]
    v_mfma_f32_16x16x32_bf16 v[136:139], a[184:187], v[96:99], v[136:139]
    v_mfma_f32_16x16x32_bf16 v[140:143], a[184:187], v[100:103], v[140:143]
    v_cvt_pk_bf16_f32 v128, v128, v129
    v_cvt_pk_bf16_f32 v129, v130, v131
    v_cvt_pk_bf16_f32 v130, v132, v133
    v_cvt_pk_bf16_f32 v131, v134, v135
    buffer_store_dwordx4 v[128:131], v1, s[48:51], s64 offen offset:0 sc1
    v_mfma_f32_16x16x32_bf16 v[136:139], a[220:223], v[104:107], v[136:139]
    v_mfma_f32_16x16x32_bf16 v[140:143], a[220:223], v[108:111], v[140:143]
    v_mfma_f32_16x16x32_bf16 v[136:139], a[4:7], v[112:115], v[136:139]
    v_mfma_f32_16x16x32_bf16 v[140:143], a[4:7], v[116:119], v[140:143]
    v_mfma_f32_16x16x32_bf16 v[136:139], v[36:39], v[120:123], v[136:139]
    v_mfma_f32_16x16x32_bf16 v[140:143], v[36:39], v[124:127], v[140:143]
    v_mfma_f32_16x16x32_bf16 v[144:147], a[44:47], v[64:67], v[144:147]
    v_mfma_f32_16x16x32_bf16 v[148:151], a[44:47], v[68:71], v[148:151]
    s_mul_i32 s65, s54, 288
    s_lshl_b32 s66, s52, 6
    s_add_u32 s66, s65, s66
    v_add_u32 v2, s66, v0
    v_and_b32 v255, 31, v0
    s_add_u32 s65, s65, 256
    v_add_u32 v255, s65, v255
    v_and_b32 v4, 15, v2
    v_mul_u32_u24 v4, 1152, v4
    v_lshrrev_b32 v6, 6, v2
    v_lshl_add_u32 v4, v6, 5, v4
    v_bfe_u32 v6, v2, 4, 2
    v_lshl_add_u32 v4, v6, 3, v4
    v_and_b32 v5, 15, v255
    v_mul_u32_u24 v5, 1152, v5
    v_lshrrev_b32 v6, 6, v255
    v_lshl_add_u32 v5, v6, 5, v5
    v_bfe_u32 v6, v255, 4, 2
    v_lshl_add_u32 v5, v6, 3, v5
    v_lshlrev_b32 v2, 4, v2
    v_lshlrev_b32 v255, 4, v255
    v_lshrrev_b32 v6, 5, v0
    s_mov_b32 s65, 147456
    v_mul_lo_u32 v6, s65, v6
    v_add_u32 v255, v255, v6
    v_mfma_f32_16x16x32_bf16 v[144:147], a[80:83], v[72:75], v[144:147]
    v_mfma_f32_16x16x32_bf16 v[148:151], a[80:83], v[76:79], v[148:151]
    v_mfma_f32_16x16x32_bf16 v[144:147], a[116:119], v[80:83], v[144:147]
    v_mfma_f32_16x16x32_bf16 v[148:151], a[116:119], v[84:87], v[148:151]
    v_mfma_f32_16x16x32_bf16 v[144:147], a[152:155], v[88:91], v[144:147]
    v_mfma_f32_16x16x32_bf16 v[148:151], a[152:155], v[92:95], v[148:151]
    v_mfma_f32_16x16x32_bf16 v[144:147], a[188:191], v[96:99], v[144:147]
    v_mfma_f32_16x16x32_bf16 v[148:151], a[188:191], v[100:103], v[148:151]
    v_cvt_pk_bf16_f32 v136, v136, v137
    v_cvt_pk_bf16_f32 v137, v138, v139
    v_cvt_pk_bf16_f32 v138, v140, v141
    v_cvt_pk_bf16_f32 v139, v142, v143
    buffer_store_dwordx4 v[136:139], v1, s[48:51], s64 offen offset:1024 sc1
    v_mfma_f32_16x16x32_bf16 v[144:147], a[224:227], v[104:107], v[144:147]
    v_mfma_f32_16x16x32_bf16 v[148:151], a[224:227], v[108:111], v[148:151]
    v_mfma_f32_16x16x32_bf16 v[144:147], a[8:11], v[112:115], v[144:147]
    v_mfma_f32_16x16x32_bf16 v[148:151], a[8:11], v[116:119], v[148:151]
    v_mfma_f32_16x16x32_bf16 v[144:147], v[40:43], v[120:123], v[144:147]
    v_mfma_f32_16x16x32_bf16 v[148:151], v[40:43], v[124:127], v[148:151]
    v_mfma_f32_16x16x32_bf16 v[152:155], a[48:51], v[64:67], v[152:155]
    v_mfma_f32_16x16x32_bf16 v[156:159], a[48:51], v[68:71], v[156:159]
    v_mfma_f32_16x16x32_bf16 v[152:155], a[84:87], v[72:75], v[152:155]
    v_mfma_f32_16x16x32_bf16 v[156:159], a[84:87], v[76:79], v[156:159]
    v_mfma_f32_16x16x32_bf16 v[152:155], a[120:123], v[80:83], v[152:155]
    v_mfma_f32_16x16x32_bf16 v[156:159], a[120:123], v[84:87], v[156:159]
    v_mfma_f32_16x16x32_bf16 v[152:155], a[156:159], v[88:91], v[152:155]
    v_mfma_f32_16x16x32_bf16 v[156:159], a[156:159], v[92:95], v[156:159]
    v_mfma_f32_16x16x32_bf16 v[152:155], a[192:195], v[96:99], v[152:155]
    v_mfma_f32_16x16x32_bf16 v[156:159], a[192:195], v[100:103], v[156:159]
    v_cvt_pk_bf16_f32 v144, v144, v145
    v_cvt_pk_bf16_f32 v145, v146, v147
    v_cvt_pk_bf16_f32 v146, v148, v149
    v_cvt_pk_bf16_f32 v147, v150, v151
    buffer_store_dwordx4 v[144:147], v1, s[48:51], s64 offen offset:2048 sc1
    v_mfma_f32_16x16x32_bf16 v[152:155], a[228:231], v[104:107], v[152:155]
    v_mfma_f32_16x16x32_bf16 v[156:159], a[228:231], v[108:111], v[156:159]
    v_mfma_f32_16x16x32_bf16 v[152:155], a[12:15], v[112:115], v[152:155]
    v_mfma_f32_16x16x32_bf16 v[156:159], a[12:15], v[116:119], v[156:159]
    v_mfma_f32_16x16x32_bf16 v[152:155], v[44:47], v[120:123], v[152:155]
    v_mfma_f32_16x16x32_bf16 v[156:159], v[44:47], v[124:127], v[156:159]
    v_mfma_f32_16x16x32_bf16 v[160:163], a[52:55], v[64:67], v[160:163]
    v_mfma_f32_16x16x32_bf16 v[164:167], a[52:55], v[68:71], v[164:167]
    v_mfma_f32_16x16x32_bf16 v[160:163], a[88:91], v[72:75], v[160:163]
    v_mfma_f32_16x16x32_bf16 v[164:167], a[88:91], v[76:79], v[164:167]
    v_mfma_f32_16x16x32_bf16 v[160:163], a[124:127], v[80:83], v[160:163]
    v_mfma_f32_16x16x32_bf16 v[164:167], a[124:127], v[84:87], v[164:167]
    v_mfma_f32_16x16x32_bf16 v[160:163], a[160:163], v[88:91], v[160:163]
    v_mfma_f32_16x16x32_bf16 v[164:167], a[160:163], v[92:95], v[164:167]
    v_mfma_f32_16x16x32_bf16 v[160:163], a[196:199], v[96:99], v[160:163]
    v_mfma_f32_16x16x32_bf16 v[164:167], a[196:199], v[100:103], v[164:167]
    v_cvt_pk_bf16_f32 v152, v152, v153
    v_cvt_pk_bf16_f32 v153, v154, v155
    v_cvt_pk_bf16_f32 v154, v156, v157
    v_cvt_pk_bf16_f32 v155, v158, v159
    buffer_store_dwordx4 v[152:155], v1, s[48:51], s64 offen offset:3072 sc1
    v_mfma_f32_16x16x32_bf16 v[160:163], a[232:235], v[104:107], v[160:163]
    v_mfma_f32_16x16x32_bf16 v[164:167], a[232:235], v[108:111], v[164:167]
    v_mfma_f32_16x16x32_bf16 v[160:163], a[16:19], v[112:115], v[160:163]
    v_mfma_f32_16x16x32_bf16 v[164:167], a[16:19], v[116:119], v[164:167]
    v_mfma_f32_16x16x32_bf16 v[160:163], v[48:51], v[120:123], v[160:163]
    v_mfma_f32_16x16x32_bf16 v[164:167], v[48:51], v[124:127], v[164:167]
    v_mfma_f32_16x16x32_bf16 v[168:171], a[56:59], v[64:67], v[168:171]
    v_mfma_f32_16x16x32_bf16 v[172:175], a[56:59], v[68:71], v[172:175]
    v_mfma_f32_16x16x32_bf16 v[168:171], a[92:95], v[72:75], v[168:171]
    v_mfma_f32_16x16x32_bf16 v[172:175], a[92:95], v[76:79], v[172:175]
    v_mfma_f32_16x16x32_bf16 v[168:171], a[128:131], v[80:83], v[168:171]
    v_mfma_f32_16x16x32_bf16 v[172:175], a[128:131], v[84:87], v[172:175]
    v_mfma_f32_16x16x32_bf16 v[168:171], a[164:167], v[88:91], v[168:171]
    v_mfma_f32_16x16x32_bf16 v[172:175], a[164:167], v[92:95], v[172:175]
    v_mfma_f32_16x16x32_bf16 v[168:171], a[200:203], v[96:99], v[168:171]
    v_mfma_f32_16x16x32_bf16 v[172:175], a[200:203], v[100:103], v[172:175]
    v_cvt_pk_bf16_f32 v160, v160, v161
    v_cvt_pk_bf16_f32 v161, v162, v163
    v_cvt_pk_bf16_f32 v162, v164, v165
    v_cvt_pk_bf16_f32 v163, v166, v167
    s_add_u32 s64, s64, 4096
    buffer_store_dwordx4 v[160:163], v1, s[48:51], s64 offen offset:0 sc1
    v_mfma_f32_16x16x32_bf16 v[168:171], a[236:239], v[104:107], v[168:171]
    v_mfma_f32_16x16x32_bf16 v[172:175], a[236:239], v[108:111], v[172:175]
    v_mfma_f32_16x16x32_bf16 v[168:171], a[20:23], v[112:115], v[168:171]
    v_mfma_f32_16x16x32_bf16 v[172:175], a[20:23], v[116:119], v[172:175]
    v_mfma_f32_16x16x32_bf16 v[168:171], v[52:55], v[120:123], v[168:171]
    v_mfma_f32_16x16x32_bf16 v[172:175], v[52:55], v[124:127], v[172:175]
    v_mfma_f32_16x16x32_bf16 v[176:179], a[60:63], v[64:67], v[176:179]
    v_mfma_f32_16x16x32_bf16 v[180:183], a[60:63], v[68:71], v[180:183]
    v_mfma_f32_16x16x32_bf16 v[176:179], a[96:99], v[72:75], v[176:179]
    v_mfma_f32_16x16x32_bf16 v[180:183], a[96:99], v[76:79], v[180:183]
    v_mfma_f32_16x16x32_bf16 v[176:179], a[132:135], v[80:83], v[176:179]
    v_mfma_f32_16x16x32_bf16 v[180:183], a[132:135], v[84:87], v[180:183]
    v_mfma_f32_16x16x32_bf16 v[176:179], a[168:171], v[88:91], v[176:179]
    v_mfma_f32_16x16x32_bf16 v[180:183], a[168:171], v[92:95], v[180:183]
    v_mfma_f32_16x16x32_bf16 v[176:179], a[204:207], v[96:99], v[176:179]
    v_mfma_f32_16x16x32_bf16 v[180:183], a[204:207], v[100:103], v[180:183]
    v_cvt_pk_bf16_f32 v168, v168, v169
    v_cvt_pk_bf16_f32 v169, v170, v171
    v_cvt_pk_bf16_f32 v170, v172, v173
    v_cvt_pk_bf16_f32 v171, v174, v175
    buffer_store_dwordx4 v[168:171], v1, s[48:51], s64 offen offset:1024 sc1
    v_mfma_f32_16x16x32_bf16 v[176:179], a[240:243], v[104:107], v[176:179]
    v_mfma_f32_16x16x32_bf16 v[180:183], a[240:243], v[108:111], v[180:183]
    v_mfma_f32_16x16x32_bf16 v[176:179], a[24:27], v[112:115], v[176:179]
    v_mfma_f32_16x16x32_bf16 v[180:183], a[24:27], v[116:119], v[180:183]
    v_mfma_f32_16x16x32_bf16 v[176:179], v[56:59], v[120:123], v[176:179]
    v_mfma_f32_16x16x32_bf16 v[180:183], v[56:59], v[124:127], v[180:183]
    v_mfma_f32_16x16x32_bf16 v[184:187], a[64:67], v[64:67], v[184:187]
    v_mfma_f32_16x16x32_bf16 v[188:191], a[64:67], v[68:71], v[188:191]
    v_mfma_f32_16x16x32_bf16 v[184:187], a[100:103], v[72:75], v[184:187]
    v_mfma_f32_16x16x32_bf16 v[188:191], a[100:103], v[76:79], v[188:191]
    v_mfma_f32_16x16x32_bf16 v[184:187], a[136:139], v[80:83], v[184:187]
    v_mfma_f32_16x16x32_bf16 v[188:191], a[136:139], v[84:87], v[188:191]
    v_mfma_f32_16x16x32_bf16 v[184:187], a[172:175], v[88:91], v[184:187]
    v_mfma_f32_16x16x32_bf16 v[188:191], a[172:175], v[92:95], v[188:191]
    v_mfma_f32_16x16x32_bf16 v[184:187], a[208:211], v[96:99], v[184:187]
    v_mfma_f32_16x16x32_bf16 v[188:191], a[208:211], v[100:103], v[188:191]
    v_cvt_pk_bf16_f32 v176, v176, v177
    v_cvt_pk_bf16_f32 v177, v178, v179
    v_cvt_pk_bf16_f32 v178, v180, v181
    v_cvt_pk_bf16_f32 v179, v182, v183
    buffer_store_dwordx4 v[176:179], v1, s[48:51], s64 offen offset:2048 sc1
    v_mfma_f32_16x16x32_bf16 v[184:187], a[244:247], v[104:107], v[184:187]
    v_mfma_f32_16x16x32_bf16 v[188:191], a[244:247], v[108:111], v[188:191]
    v_mfma_f32_16x16x32_bf16 v[184:187], a[28:31], v[112:115], v[184:187]
    v_mfma_f32_16x16x32_bf16 v[188:191], a[28:31], v[116:119], v[188:191]
    v_mfma_f32_16x16x32_bf16 v[184:187], v[60:63], v[120:123], v[184:187]
    v_mfma_f32_16x16x32_bf16 v[188:191], v[60:63], v[124:127], v[188:191]
    v_mfma_f32_16x16x32_bf16 v[192:195], a[68:71], v[64:67], v[192:195]
    v_mfma_f32_16x16x32_bf16 v[196:199], a[68:71], v[68:71], v[196:199]
    v_mfma_f32_16x16x32_bf16 v[192:195], a[104:107], v[72:75], v[192:195]
    v_mfma_f32_16x16x32_bf16 v[196:199], a[104:107], v[76:79], v[196:199]
    v_mfma_f32_16x16x32_bf16 v[192:195], a[140:143], v[80:83], v[192:195]
    v_mfma_f32_16x16x32_bf16 v[196:199], a[140:143], v[84:87], v[196:199]
    v_mfma_f32_16x16x32_bf16 v[192:195], a[176:179], v[88:91], v[192:195]
    v_mfma_f32_16x16x32_bf16 v[196:199], a[176:179], v[92:95], v[196:199]
    v_mfma_f32_16x16x32_bf16 v[192:195], a[212:215], v[96:99], v[192:195]
    v_mfma_f32_16x16x32_bf16 v[196:199], a[212:215], v[100:103], v[196:199]
    v_cvt_pk_bf16_f32 v184, v184, v185
    v_cvt_pk_bf16_f32 v185, v186, v187
    v_cvt_pk_bf16_f32 v186, v188, v189
    v_cvt_pk_bf16_f32 v187, v190, v191
    buffer_store_dwordx4 v[184:187], v1, s[48:51], s64 offen offset:3072 sc1
    v_mfma_f32_16x16x32_bf16 v[192:195], a[248:251], v[104:107], v[192:195]
    v_mfma_f32_16x16x32_bf16 v[196:199], a[248:251], v[108:111], v[196:199]
    v_mfma_f32_16x16x32_bf16 v[192:195], a[32:35], v[112:115], v[192:195]
    v_mfma_f32_16x16x32_bf16 v[196:199], a[32:35], v[116:119], v[196:199]
    v_mfma_f32_16x16x32_bf16 v[192:195], v[200:203], v[120:123], v[192:195]
    v_mfma_f32_16x16x32_bf16 v[196:199], v[200:203], v[124:127], v[196:199]
    s_lshl_b32 s65, s54, 3
    v_mov_b32 v254, s65
    v_lshlrev_b32 v3, 3, v0
    v_mov_b32 v253, 64
    s_nop 3
    v_cvt_pk_bf16_f32 v192, v192, v193
    v_cvt_pk_bf16_f32 v193, v194, v195
    v_cvt_pk_bf16_f32 v194, v196, v197
    v_cvt_pk_bf16_f32 v195, v198, v199
    s_add_u32 s64, s64, 4096
    buffer_store_dwordx4 v[192:195], v1, s[48:51], s64 offen offset:0 sc1
    s_cmp_lg_u32 s98, 0
    s_cbranch_scc1 L_PUBD
    s_cmp_lg_u32 s52, 0
    s_cbranch_scc1 L_GONE
    s_mov_b64 exec, 1
    s_mov_b32 s66, 0x4000
L_GPOLL:
    buffer_load_dwordx2 v[6:7], v253, s[48:51], s67 offen sc1
    s_sub_u32 s66, s66, 1
    s_cmp_eq_u32 s66, 0
    s_cbranch_scc1 L_GOUT
    s_waitcnt vmcnt(0)
    v_cmp_ne_u64 vcc, v[244:245], v[6:7]
    s_nop 1
    s_cbranch_vccz L_GOUT
    s_sleep 2
    s_branch L_GPOLL
L_GOUT:
    s_mov_b64 exec, -1
L_GONE:
    s_barrier
    buffer_store_dwordx4 v[128:131], v1, s[48:51], s76 offen offset:0 sc1
    buffer_store_dwordx4 v[136:139], v1, s[48:51], s76 offen offset:1024 sc1
    buffer_store_dwordx4 v[144:147], v1, s[48:51], s76 offen offset:2048 sc1
    buffer_store_dwordx4 v[152:155], v1, s[48:51], s76 offen offset:3072 sc1
    s_add_u32 s76, s76, 4096
    buffer_store_dwordx4 v[160:163], v1, s[48:51], s76 offen offset:0 sc1
    buffer_store_dwordx4 v[168:171], v1, s[48:51], s76 offen offset:1024 sc1
    buffer_store_dwordx4 v[176:179], v1, s[48:51], s76 offen offset:2048 sc1
    buffer_store_dwordx4 v[184:187], v1, s[48:51], s76 offen offset:3072 sc1
    s_add_u32 s76, s76, 4096
    buffer_store_dwordx4 v[192:195], v1, s[48:51], s76 offen offset:0 sc1
L_PUBD:
    s_mul_i32 s64, s53, 294912
    s_mov_b32 s65, 0xffff0000
    s_waitcnt vmcnt(0)
    s_barrier
    v_mov_b32 v253, 151552
    s_cmp_lg_u32 s52, 0
    s_cbranch_scc1 L_POLLED
    s_mov_b64 exec, 1
    buffer_store_dwordx2 v[244:245], v254, s[48:51], s67 offen sc1
    s_mov_b64 exec, 0xff
    s_mov_b32 s66, 0x400000
L_POLL:
    buffer_load_dwordx2 v[6:7], v3, s[48:51], s67 offen sc1
    s_waitcnt vmcnt(0)
    v_cmp_eq_u64 vcc, v[244:245], v[6:7]
    s_sub_u32 s66, s66, 1
    s_cmp_eq_u32 s66, 0
    s_cbranch_scc1 L_POLL_X
    s_bcnt1_i32_b32 s75, vcc_lo
    s_cmp_ge_u32 s75, 8
    s_cbranch_scc1 L_POLL_X
    s_sleep 2
    s_branch L_POLL
L_POLL_X:
    s_mov_b64 exec, -1
    v_mov_b32 v247, vcc_lo
    ds_write_b32 v253, v247
    s_waitcnt lgkmcnt(0)
L_POLLED:
    s_barrier
    ds_read_b32 v247, v253
    s_waitcnt lgkmcnt(0)
    v_readfirstlane_b32 s74, v247
    s_nop 0
    s_bitcmp1_b32 s74, 0
    s_cbranch_scc0 L_SA0
    s_add_u32 s66, s64, 0
    buffer_load_dwordx4 v[32:35], v2, s[48:51], s66 offen sc1
    s_cmp_lg_u32 s52, 0
    s_cbranch_scc1 L_SA0
    s_add_u32 s66, s64, 0
    s_mov_b32 exec_lo, -1
    s_mov_b32 exec_hi, 0
    buffer_load_dwordx4 v[64:67], v255, s[48:51], s66 offen sc1
    s_mov_b64 exec, -1
L_SA0:
    s_bitcmp1_b32 s74, 1
    s_cbranch_scc0 L_SA1
    s_add_u32 s66, s64, 36864
    buffer_load_dwordx4 v[36:39], v2, s[48:51], s66 offen sc1
    s_cmp_lg_u32 s52, 0
    s_cbranch_scc1 L_SA1
    s_add_u32 s66, s64, 36864
    s_mov_b32 exec_lo, -1
    s_mov_b32 exec_hi, 0
    buffer_load_dwordx4 v[68:71], v255, s[48:51], s66 offen sc1
    s_mov_b64 exec, -1
L_SA1:
    s_bitcmp1_b32 s74, 2
    s_cbranch_scc0 L_SA2
    s_add_u32 s66, s64, 73728
    buffer_load_dwordx4 v[40:43], v2, s[48:51], s66 offen sc1
    s_cmp_lg_u32 s52, 0
    s_cbranch_scc1 L_SA2
    s_add_u32 s66, s64, 73728
    s_mov_b32 exec_lo, -1
    s_mov_b32 exec_hi, 0
    buffer_load_dwordx4 v[72:75], v255, s[48:51], s66 offen sc1
    s_mov_b64 exec, -1
L_SA2:
    s_bitcmp1_b32 s74, 3
    s_cbranch_scc0 L_SA3
    s_add_u32 s66, s64, 110592
    buffer_load_dwordx4 v[44:47], v2, s[48:51], s66 offen sc1
    s_cmp_lg_u32 s52, 0
    s_cbranch_scc1 L_SA3
    s_add_u32 s66, s64, 110592
    s_mov_b32 exec_lo, -1
    s_mov_b32 exec_hi, 0
    buffer_load_dwordx4 v[76:79], v255, s[48:51], s66 offen sc1
    s_mov_b64 exec, -1
L_SA3:
    s_bitcmp1_b32 s74, 4
    s_cbranch_scc0 L_SA4
    s_add_u32 s66, s64, 147456
    buffer_load_dwordx4 v[48:51], v2, s[48:51], s66 offen sc1
    s_cmp_lg_u32 s52, 0
    s_cbranch_scc1 L_SA4
    s_add_u32 s66, s64, 0
    s_mov_b32 exec_lo, 0
    s_mov_b32 exec_hi, -1
    buffer_load_dwordx4 v[64:67], v255, s[48:51], s66 offen sc1
    s_mov_b64 exec, -1
L_SA4:
    s_bitcmp1_b32 s74, 5
    s_cbranch_scc0 L_SA5
    s_add_u32 s66, s64, 184320
    buffer_load_dwordx4 v[52:55], v2, s[48:51], s66 offen sc1
    s_cmp_lg_u32 s52, 0
    s_cbranch_scc1 L_SA5
    s_add_u32 s66, s64, 36864
    s_mov_b32 exec_lo, 0
    s_mov_b32 exec_hi, -1
    buffer_load_dwordx4 v[68:71], v255, s[48:51], s66 offen sc1
    s_mov_b64 exec, -1
L_SA5:
    s_bitcmp1_b32 s74, 6
    s_cbranch_scc0 L_SA6
    s_add_u32 s66, s64, 221184
    buffer_load_dwordx4 v[56:59], v2, s[48:51], s66 offen sc1
    s_cmp_lg_u32 s52, 0
    s_cbranch_scc1 L_SA6
    s_add_u32 s66, s64, 73728
    s_mov_b32 exec_lo, 0
    s_mov_b32 exec_hi, -1
    buffer_load_dwordx4 v[72:75], v255, s[48:51], s66 offen sc1
    s_mov_b64 exec, -1
L_SA6:
    s_bitcmp1_b32 s74, 7
    s_cbranch_scc0 L_SA7
    s_add_u32 s66, s64, 258048
    buffer_load_dwordx4 v[60:63], v2, s[48:51], s66 offen sc1
    s_cmp_lg_u32 s52, 0
    s_cbranch_scc1 L_SA7
    s_add_u32 s66, s64, 110592
    s_mov_b32 exec_lo, 0
    s_mov_b32 exec_hi, -1
    buffer_load_dwordx4 v[76:79], v255, s[48:51], s66 offen sc1
    s_mov_b64 exec, -1
L_SA7:
    s_cmp_eq_u32 s74, 0xff
    s_cbranch_scc1 L_ALLIN
    s_cmp_lg_u32 s52, 0
    s_cbranch_scc1 L_POLLED2
    s_mov_b64 exec, 0xff
    s_mov_b32 s66, 0x400000
L_POLL2:
    buffer_load_dwordx2 v[6:7], v3, s[48:51], s67 offen sc1
    s_waitcnt vmcnt(0)
    v_cmp_eq_u64 vcc, v[244:245], v[6:7]
    s_sub_u32 s66, s66, 1
    s_cmp_eq_u32 s66, 0
    s_cbranch_scc1 L_POLL2_X
    s_bcnt1_i32_b32 s75, vcc_lo
    s_cmp_ge_u32 s75, 8
    s_cbranch_scc1 L_POLL2_X
    s_sleep 2
    s_branch L_POLL2
L_POLL2_X:
    s_mov_b64 exec, -1
L_POLLED2:
    s_barrier
    s_not_b32 s74, s74
    s_bitcmp1_b32 s74, 0
    s_cbranch_scc0 L_SB0
    s_add_u32 s66, s64, 0
    buffer_load_dwordx4 v[32:35], v2, s[48:51], s66 offen sc1
    s_cmp_lg_u32 s52, 0
    s_cbranch_scc1 L_SB0
    s_add_u32 s66, s64, 0
    s_mov_b32 exec_lo, -1
    s_mov_b32 exec_hi, 0
    buffer_load_dwordx4 v[64:67], v255, s[48:51], s66 offen sc1
    s_mov_b64 exec, -1
L_SB0:
    s_bitcmp1_b32 s74, 1
    s_cbranch_scc0 L_SB1
    s_add_u32 s66, s64, 36864
    buffer_load_dwordx4 v[36:39], v2, s[48:51], s66 offen sc1
    s_cmp_lg_u32 s52, 0
    s_cbranch_scc1 L_SB1
    s_add_u32 s66, s64, 36864
    s_mov_b32 exec_lo, -1
    s_mov_b32 exec_hi, 0
    buffer_load_dwordx4 v[68:71], v255, s[48:51], s66 offen sc1
    s_mov_b64 exec, -1
L_SB1:
    s_bitcmp1_b32 s74, 2
    s_cbranch_scc0 L_SB2
    s_add_u32 s66, s64, 73728
    buffer_load_dwordx4 v[40:43], v2, s[48:51], s66 offen sc1
    s_cmp_lg_u32 s52, 0
    s_cbranch_scc1 L_SB2
    s_add_u32 s66, s64, 73728
    s_mov_b32 exec_lo, -1
    s_mov_b32 exec_hi, 0
    buffer_load_dwordx4 v[72:75], v255, s[48:51], s66 offen sc1
    s_mov_b64 exec, -1
L_SB2:
    s_bitcmp1_b32 s74, 3
    s_cbranch_scc0 L_SB3
    s_add_u32 s66, s64, 110592
    buffer_load_dwordx4 v[44:47], v2, s[48:51], s66 offen sc1
    s_cmp_lg_u32 s52, 0
    s_cbranch_scc1 L_SB3
    s_add_u32 s66, s64, 110592
    s_mov_b32 exec_lo, -1
    s_mov_b32 exec_hi, 0
    buffer_load_dwordx4 v[76:79], v255, s[48:51], s66 offen sc1
    s_mov_b64 exec, -1
L_SB3:
    s_bitcmp1_b32 s74, 4
    s_cbranch_scc0 L_SB4
    s_add_u32 s66, s64, 147456
    buffer_load_dwordx4 v[48:51], v2, s[48:51], s66 offen sc1
    s_cmp_lg_u32 s52, 0
    s_cbranch_scc1 L_SB4
    s_add_u32 s66, s64, 0
    s_mov_b32 exec_lo, 0
    s_mov_b32 exec_hi, -1
    buffer_load_dwordx4 v[64:67], v255, s[48:51], s66 offen sc1
    s_mov_b64 exec, -1
L_SB4:
    s_bitcmp1_b32 s74, 5
    s_cbranch_scc0 L_SB5
    s_add_u32 s66, s64, 184320
    buffer_load_dwordx4 v[52:55], v2, s[48:51], s66 offen sc1
    s_cmp_lg_u32 s52, 0
    s_cbranch_scc1 L_SB5
    s_add_u32 s66, s64, 36864
    s_mov_b32 exec_lo, 0
    s_mov_b32 exec_hi, -1
    buffer_load_dwordx4 v[68:71], v255, s[48:51], s66 offen sc1
    s_mov_b64 exec, -1
L_SB5:
    s_bitcmp1_b32 s74, 6
    s_cbranch_scc0 L_SB6
    s_add_u32 s66, s64, 221184
    buffer_load_dwordx4 v[56:59], v2, s[48:51], s66 offen sc1
    s_cmp_lg_u32 s52, 0
    s_cbranch_scc1 L_SB6
    s_add_u32 s66, s64, 73728
    s_mov_b32 exec_lo, 0
    s_mov_b32 exec_hi, -1
    buffer_load_dwordx4 v[72:75], v255, s[48:51], s66 offen sc1
    s_mov_b64 exec, -1
L_SB6:
    s_bitcmp1_b32 s74, 7
    s_cbranch_scc0 L_SB7
    s_add_u32 s66, s64, 258048
    buffer_load_dwordx4 v[60:63], v2, s[48:51], s66 offen sc1
    s_cmp_lg_u32 s52, 0
    s_cbranch_scc1 L_SB7
    s_add_u32 s66, s64, 110592
    s_mov_b32 exec_lo, 0
    s_mov_b32 exec_hi, -1
    buffer_load_dwordx4 v[76:79], v255, s[48:51], s66 offen sc1
    s_mov_b64 exec, -1
L_SB7:
L_ALLIN:
    s_mul_i32 s67, s53, 36864
    s_add_u32 s66, s67, 18432
    s_waitcnt vmcnt(0)
    v_lshlrev_b32 v128, 16, v32
    v_and_b32 v129, s65, v32
    v_lshlrev_b32 v130, 16, v33
    v_and_b32 v131, s65, v33
    v_lshlrev_b32 v132, 16, v34
    v_and_b32 v133, s65, v34
    v_lshlrev_b32 v134, 16, v35
    v_and_b32 v135, s65, v35
    v_lshlrev_b32 v8, 16, v36
    v_and_b32 v9, s65, v36
    v_lshlrev_b32 v10, 16, v37
    v_and_b32 v11, s65, v37
    v_lshlrev_b32 v12, 16, v38
    v_and_b32 v13, s65, v38
    v_lshlrev_b32 v14, 16, v39
    v_and_b32 v15, s65, v39
    v_pk_add_f32 v[128:129], v[128:129], v[8:9]
    v_pk_add_f32 v[130:131], v[130:131], v[10:11]
    v_pk_add_f32 v[132:133], v[132:133], v[12:13]
    v_pk_add_f32 v[134:135], v[134:135], v[14:15]
    v_lshlrev_b32 v8, 16, v40
    v_and_b32 v9, s65, v40
    v_lshlrev_b32 v10, 16, v41
    v_and_b32 v11, s65, v41
    v_lshlrev_b32 v12, 16, v42
    v_and_b32 v13, s65, v42
    v_lshlrev_b32 v14, 16, v43
    v_and_b32 v15, s65, v43
    v_pk_add_f32 v[128:129], v[128:129], v[8:9]
    v_pk_add_f32 v[130:131], v[130:131], v[10:11]
    v_pk_add_f32 v[132:133], v[132:133], v[12:13]
    v_pk_add_f32 v[134:135], v[134:135], v[14:15]
    v_lshlrev_b32 v8, 16, v44
    v_and_b32 v9, s65, v44
    v_lshlrev_b32 v10, 16, v45
    v_and_b32 v11, s65, v45
    v_lshlrev_b32 v12, 16, v46
    v_and_b32 v13, s65, v46
    v_lshlrev_b32 v14, 16, v47
    v_and_b32 v15, s65, v47
    v_pk_add_f32 v[128:129], v[128:129], v[8:9]
    v_pk_add_f32 v[130:131], v[130:131], v[10:11]
    v_pk_add_f32 v[132:133], v[132:133], v[12:13]
    v_pk_add_f32 v[134:135], v[134:135], v[14:15]
    v_lshlrev_b32 v8, 16, v48
    v_and_b32 v9, s65, v48
    v_lshlrev_b32 v10, 16, v49
    v_and_b32 v11, s65, v49
    v_lshlrev_b32 v12, 16, v50
    v_and_b32 v13, s65, v50
    v_lshlrev_b32 v14, 16, v51
    v_and_b32 v15, s65, v51
    v_pk_add_f32 v[128:129], v[128:129], v[8:9]
    v_pk_add_f32 v[130:131], v[130:131], v[10:11]
    v_pk_add_f32 v[132:133], v[132:133], v[12:13]
    v_pk_add_f32 v[134:135], v[134:135], v[14:15]
    v_lshlrev_b32 v8, 16, v52
    v_and_b32 v9, s65, v52
    v_lshlrev_b32 v10, 16, v53
    v_and_b32 v11, s65, v53
    v_lshlrev_b32 v12, 16, v54
    v_and_b32 v13, s65, v54
    v_lshlrev_b32 v14, 16, v55
    v_and_b32 v15, s65, v55
    v_pk_add_f32 v[128:129], v[128:129], v[8:9]
    v_pk_add_f32 v[130:131], v[130:131], v[10:11]
    v_pk_add_f32 v[132:133], v[132:133], v[12:13]
    v_pk_add_f32 v[134:135], v[134:135], v[14:15]
    v_lshlrev_b32 v8, 16, v56
    v_and_b32 v9, s65, v56
    v_lshlrev_b32 v10, 16, v57
    v_and_b32 v11, s65, v57
    v_lshlrev_b32 v12, 16, v58
    v_and_b32 v13, s65, v58
    v_lshlrev_b32 v14, 16, v59
    v_and_b32 v15, s65, v59
    v_pk_add_f32 v[128:129], v[128:129], v[8:9]
    v_pk_add_f32 v[130:131], v[130:131], v[10:11]
    v_pk_add_f32 v[132:133], v[132:133], v[12:13]
    v_pk_add_f32 v[134:135], v[134:135], v[14:15]
    v_lshlrev_b32 v8, 16, v60
    v_and_b32 v9, s65, v60
    v_lshlrev_b32 v10, 16, v61
    v_and_b32 v11, s65, v61
    v_lshlrev_b32 v12, 16, v62
    v_and_b32 v13, s65, v62
    v_lshlrev_b32 v14, 16, v63
    v_and_b32 v15, s65, v63
    v_pk_add_f32 v[128:129], v[128:129], v[8:9]
    v_pk_add_f32 v[130:131], v[130:131], v[10:11]
    v_pk_add_f32 v[132:133], v[132:133], v[12:13]
    v_pk_add_f32 v[134:135], v[134:135], v[14:15]
    v_cvt_pk_bf16_f32 v128, v128, v129
    v_cvt_pk_bf16_f32 v129, v130, v131
    v_cvt_pk_bf16_f32 v130, v132, v133
    v_cvt_pk_bf16_f32 v131, v134, v135
    buffer_store_dwordx2 v[128:129], v4, s[40:43], s67 offen sc1
    buffer_store_dwordx2 v[130:131], v4, s[40:43], s66 offen sc1
    s_cmp_lg_u32 s52, 0
    s_cbranch_scc1 L_NO3B
    v_lshlrev_b32 v136, 16, v64
    v_and_b32 v137, s65, v64
    v_lshlrev_b32 v138, 16, v65
    v_and_b32 v139, s65, v65
    v_lshlrev_b32 v140, 16, v66
    v_and_b32 v141, s65, v66
    v_lshlrev_b32 v142, 16, v67
    v_and_b32 v143, s65, v67
    v_lshlrev_b32 v8, 16, v68
    v_and_b32 v9, s65, v68
    v_lshlrev_b32 v10, 16, v69
    v_and_b32 v11, s65, v69
    v_lshlrev_b32 v12, 16, v70
    v_and_b32 v13, s65, v70
    v_lshlrev_b32 v14, 16, v71
    v_and_b32 v15, s65, v71
    v_pk_add_f32 v[136:137], v[136:137], v[8:9]
    v_pk_add_f32 v[138:139], v[138:139], v[10:11]
    v_pk_add_f32 v[140:141], v[140:141], v[12:13]
    v_pk_add_f32 v[142:143], v[142:143], v[14:15]
    v_lshlrev_b32 v8, 16, v72
    v_and_b32 v9, s65, v72
    v_lshlrev_b32 v10, 16, v73
    v_and_b32 v11, s65, v73
    v_lshlrev_b32 v12, 16, v74
    v_and_b32 v13, s65, v74
    v_lshlrev_b32 v14, 16, v75
    v_and_b32 v15, s65, v75
    v_pk_add_f32 v[136:137], v[136:137], v[8:9]
    v_pk_add_f32 v[138:139], v[138:139], v[10:11]
    v_pk_add_f32 v[140:141], v[140:141], v[12:13]
    v_pk_add_f32 v[142:143], v[142:143], v[14:15]
    v_lshlrev_b32 v8, 16, v76
    v_and_b32 v9, s65, v76
    v_lshlrev_b32 v10, 16, v77
    v_and_b32 v11, s65, v77
    v_lshlrev_b32 v12, 16, v78
    v_and_b32 v13, s65, v78
    v_lshlrev_b32 v14, 16, v79
    v_and_b32 v15, s65, v79
    v_pk_add_f32 v[136:137], v[136:137], v[8:9]
    v_pk_add_f32 v[138:139], v[138:139], v[10:11]
    v_pk_add_f32 v[140:141], v[140:141], v[12:13]
    v_pk_add_f32 v[142:143], v[142:143], v[14:15]
    v_mov_b32 v8, v136
    v_mov_b32 v9, v137
    v_mov_b32 v10, v138
    v_mov_b32 v11, v139
    v_mov_b32 v12, v140
    v_mov_b32 v13, v141
    v_mov_b32 v14, v142
    v_mov_b32 v15, v143
    s_nop 0
    v_permlane32_swap_b32 v136, v8
    v_permlane32_swap_b32 v137, v9
    v_permlane32_swap_b32 v138, v10
    v_permlane32_swap_b32 v139, v11
    v_permlane32_swap_b32 v140, v12
    v_permlane32_swap_b32 v141, v13
    v_permlane32_swap_b32 v142, v14
    v_permlane32_swap_b32 v143, v15
    v_pk_add_f32 v[136:137], v[136:137], v[8:9]
    v_pk_add_f32 v[138:139], v[138:139], v[10:11]
    v_pk_add_f32 v[140:141], v[140:141], v[12:13]
    v_pk_add_f32 v[142:143], v[142:143], v[14:15]
    s_mov_b64 exec, 0xffffffff
    v_cvt_pk_bf16_f32 v136, v136, v137
    v_cvt_pk_bf16_f32 v137, v138, v139
    v_cvt_pk_bf16_f32 v138, v140, v141
    v_cvt_pk_bf16_f32 v139, v142, v143
    buffer_store_dwordx2 v[136:137], v5, s[40:43], s67 offen sc1
    buffer_store_dwordx2 v[138:139], v5, s[40:43], s66 offen sc1
    s_mov_b64 exec, -1
L_NO3B:
L_END:
    s_endpgm
L_STEP:
    v_add_u32 v8, s57, v241
    ds_read_b128 v[32:35], v8
    v_xor_b32 v9, 32, v8
    ds_read_b128 v[36:39], v9
    v_xor_b32 v10, 64, v8
    ds_read_b128 v[40:43], v10
    v_xor_b32 v11, 96, v8
    ds_read_b128 v[44:47], v11
    v_xor_b32 v12, 128, v8
    ds_read_b128 v[48:51], v12
    v_xor_b32 v13, 160, v8
    ds_read_b128 v[52:55], v13
    v_xor_b32 v14, 192, v8
    ds_read_b128 v[56:59], v14
    v_xor_b32 v15, 224, v8
    ds_read_b128 v[60:63], v15
    v_add_u32 v4, s57, v242
    v_xor_b32 v5, 64, v4
    v_xor_b32 v6, 128, v4
    v_xor_b32 v7, 192, v4
    s_add_u32 s57, s57, 32768
    s_cmp_ge_u32 s57, 98304
    s_cselect_b32 s57, 0, s57
    s_mov_b32 m0, s79
    s_waitcnt vmcnt(8)
    s_nop 0
    buffer_load_dwordx4 v236, s[24:27], s78 offen offset:0 nt lds
    s_waitcnt lgkmcnt(7)
    v_mfma_f32_32x32x16_bf16 v[16:31], v[32:35], v[200:203], 0
    ds_read_b64_tr_b16 v[32:33], v4 offset:0
    ds_read_b64_tr_b16 v[34:35], v4 offset:2048
    s_waitcnt lgkmcnt(8)
    v_mfma_f32_32x32x16_bf16 v[16:31], v[36:39], v[204:207], v[16:31]
    ds_read_b64_tr_b16 v[36:37], v4 offset:4096
    ds_read_b64_tr_b16 v[38:39], v4 offset:6144
    s_waitcnt vmcnt(8)
    buffer_load_dwordx4 v236, s[24:27], s78 offen offset:1024 nt lds
    s_waitcnt lgkmcnt(9)
    v_mfma_f32_32x32x16_bf16 v[16:31], v[40:43], v[208:211], v[16:31]
    ds_read_b64_tr_b16 v[40:41], v5 offset:0
    ds_read_b64_tr_b16 v[42:43], v5 offset:2048
    s_waitcnt lgkmcnt(10)
    v_mfma_f32_32x32x16_bf16 v[16:31], v[44:47], v[212:215], v[16:31]
    ds_read_b64_tr_b16 v[44:45], v5 offset:4096
    ds_read_b64_tr_b16 v[46:47], v5 offset:6144
    s_waitcnt vmcnt(8)
    buffer_load_dwordx4 v236, s[24:27], s78 offen offset:2048 nt lds
    s_waitcnt lgkmcnt(11)
    v_mfma_f32_32x32x16_bf16 v[16:31], v[48:51], v[216:219], v[16:31]
    ds_read_b64_tr_b16 v[48:49], v6 offset:0
    ds_read_b64_tr_b16 v[50:51], v6 offset:2048
    s_waitcnt lgkmcnt(12)
    v_mfma_f32_32x32x16_bf16 v[16:31], v[52:55], v[220:223], v[16:31]
    ds_read_b64_tr_b16 v[52:53], v6 offset:4096
    ds_read_b64_tr_b16 v[54:55], v6 offset:6144
    s_waitcnt vmcnt(8)
    buffer_load_dwordx4 v236, s[24:27], s78 offen offset:3072 nt lds
    s_waitcnt lgkmcnt(13)
    v_mfma_f32_32x32x16_bf16 v[16:31], v[56:59], v[224:227], v[16:31]
    ds_read_b64_tr_b16 v[56:57], v7 offset:0
    ds_read_b64_tr_b16 v[58:59], v7 offset:2048
    s_waitcnt lgkmcnt(13)
    v_mfma_f32_32x32x16_bf16 v[16:31], v[60:63], v[228:231], v[16:31]
    ds_read_b64_tr_b16 v[60:61], v7 offset:4096
    ds_read_b64_tr_b16 v[62:63], v7 offset:6144
    s_mov_b32 m0, s56
    s_waitcnt lgkmcnt(0)
    s_barrier
    s_waitcnt vmcnt(8)
    buffer_load_dwordx4 v232, s[20:23], s55 offen offset:0 nt lds
    s_nop 4
    v_max3_f32 v1, v16, v17, v18
    v_max3_f32 v2, v19, v20, v21
    v_max3_f32 v1, v1, v22, v23
    v_max3_f32 v2, v2, v24, v25
    v_max3_f32 v1, v1, v26, v27
    v_max3_f32 v2, v2, v28, v29
    v_max3_f32 v1, v1, v30, v31
    v_max_f32 v1, v1, v2
    v_fma_f32 v2, v1, s60, -v252
    v_cmp_nge_f32 vcc, s70, v2
    s_waitcnt vmcnt(8)
    buffer_load_dwordx4 v233, s[20:23], s55 offen offset:1024 nt lds
    s_cbranch_vccnz L_STEP_R
L_STEP_C:
    v_fma_f32 v16, v16, s60, -v252
    v_fma_f32 v17, v17, s60, -v252
    v_fma_f32 v18, v18, s60, -v252
    v_fma_f32 v19, v19, s60, -v252
    v_fma_f32 v20, v20, s60, -v252
    v_fma_f32 v21, v21, s60, -v252
    v_fma_f32 v22, v22, s60, -v252
    v_fma_f32 v23, v23, s60, -v252
    v_exp_f32 v16, v16
    v_exp_f32 v17, v17
    v_exp_f32 v18, v18
    v_exp_f32 v19, v19
    s_waitcnt vmcnt(8)
    buffer_load_dwordx4 v234, s[20:23], s55 offen offset:2048 nt lds
    v_exp_f32 v20, v20
    v_exp_f32 v21, v21
    v_exp_f32 v22, v22
    v_exp_f32 v23, v23
    v_fma_f32 v24, v24, s60, -v252
    v_fma_f32 v25, v25, s60, -v252
    v_fma_f32 v26, v26, s60, -v252
    v_fma_f32 v27, v27, s60, -v252
    v_cvt_pk_bf16_f32 v8, v16, v17
    v_cvt_pk_bf16_f32 v9, v18, v19
    v_cvt_pk_bf16_f32 v10, v20, v21
    v_cvt_pk_bf16_f32 v11, v22, v23
    s_waitcnt vmcnt(8)
    buffer_load_dwordx4 v235, s[20:23], s55 offen offset:3072 nt lds
    v_fma_f32 v28, v28, s60, -v252
    v_fma_f32 v29, v29, s60, -v252
    v_fma_f32 v30, v30, s60, -v252
    v_fma_f32 v31, v31, s60, -v252
    v_mfma_f32_32x32x16_bf16 v[64:79], v[32:35], v[8:11], v[64:79]
    v_exp_f32 v24, v24
    v_exp_f32 v25, v25
    v_exp_f32 v26, v26
    v_mfma_f32_32x32x16_bf16 v[80:95], v[40:43], v[8:11], v[80:95]
    v_exp_f32 v27, v27
    v_exp_f32 v28, v28
    v_exp_f32 v29, v29
    v_mfma_f32_32x32x16_bf16 v[96:111], v[48:51], v[8:11], v[96:111]
    v_exp_f32 v30, v30
    v_exp_f32 v31, v31
    v_add_f32 v1, v16, v17
    v_mfma_f32_32x32x16_bf16 v[112:127], v[56:59], v[8:11], v[112:127]
    v_cvt_pk_bf16_f32 v12, v24, v25
    v_cvt_pk_bf16_f32 v13, v26, v27
    v_cvt_pk_bf16_f32 v14, v28, v29
    v_cvt_pk_bf16_f32 v15, v30, v31
    v_add_f32 v2, v18, v19
    v_add_f32 v1, v1, v20
    v_mfma_f32_32x32x16_bf16 v[64:79], v[36:39], v[12:15], v[64:79]
    v_add_f32 v2, v2, v21
    v_add_f32 v1, v1, v22
    v_add_f32 v2, v2, v23
    v_add_f32 v1, v1, v24
    v_add_f32 v2, v2, v25
    v_mfma_f32_32x32x16_bf16 v[80:95], v[44:47], v[12:15], v[80:95]
    v_add_f32 v1, v1, v26
    v_add_f32 v2, v2, v27
    v_add_f32 v1, v1, v28
    v_add_f32 v2, v2, v29
    v_mfma_f32_32x32x16_bf16 v[96:111], v[52:55], v[12:15], v[96:111]
    v_add_f32 v1, v1, v30
    v_add_f32 v2, v2, v31
    v_add_f32 v253, v253, v1
    v_add_f32 v253, v253, v2
    v_mfma_f32_32x32x16_bf16 v[112:127], v[60:63], v[12:15], v[112:127]
    s_mov_b32 s78, s55
    s_add_u32 s79, s56, 16384
    s_add_u32 s55, s55, 16384
    s_add_u32 s56, s56, 32768
    s_cmp_ge_u32 s56, 98304
    s_cselect_b32 s64, 98304, 0
    s_sub_u32 s56, s56, s64
    s_setpc_b64 s[58:59]
L_STEP_R:
    v_mov_b32 v2, v1
    s_nop 1
    v_permlane32_swap_b32 v1, v2
    v_max_f32 v1, v1, v2
    v_mul_f32 v1, s60, v1
    v_max_f32 v1, v1, v252
    v_sub_f32 v254, v252, v1
    v_mov_b32 v252, v1
    v_exp_f32 v254, v254
    s_nop 0
    v_mul_f32 v253, v254, v253
    v_mul_f32 v64, v254, v64
    v_mul_f32 v65, v254, v65
    v_mul_f32 v66, v254, v66
    v_mul_f32 v67, v254, v67
    v_mul_f32 v68, v254, v68
    v_mul_f32 v69, v254, v69
    v_mul_f32 v70, v254, v70
    v_mul_f32 v71, v254, v71
    v_mul_f32 v72, v254, v72
    v_mul_f32 v73, v254, v73
    v_mul_f32 v74, v254, v74
    v_mul_f32 v75, v254, v75
    v_mul_f32 v76, v254, v76
    v_mul_f32 v77, v254, v77
    v_mul_f32 v78, v254, v78
    v_mul_f32 v79, v254, v79
    v_mul_f32 v80, v254, v80
    v_mul_f32 v81, v254, v81
    v_mul_f32 v82, v254, v82
    v_mul_f32 v83, v254, v83
    v_mul_f32 v84, v254, v84
    v_mul_f32 v85, v254, v85
    v_mul_f32 v86, v254, v86
    v_mul_f32 v87, v254, v87
    v_mul_f32 v88, v254, v88
    v_mul_f32 v89, v254, v89
    v_mul_f32 v90, v254, v90
    v_mul_f32 v91, v254, v91
    v_mul_f32 v92, v254, v92
    v_mul_f32 v93, v254, v93
    v_mul_f32 v94, v254, v94
    v_mul_f32 v95, v254, v95
    v_mul_f32 v96, v254, v96
    v_mul_f32 v97, v254, v97
    v_mul_f32 v98, v254, v98
    v_mul_f32 v99, v254, v99
    v_mul_f32 v100, v254, v100
    v_mul_f32 v101, v254, v101
    v_mul_f32 v102, v254, v102
    v_mul_f32 v103, v254, v103
    v_mul_f32 v104, v254, v104
    v_mul_f32 v105, v254, v105
    v_mul_f32 v106, v254, v106
    v_mul_f32 v107, v254, v107
    v_mul_f32 v108, v254, v108
    v_mul_f32 v109, v254, v109
    v_mul_f32 v110, v254, v110
    v_mul_f32 v111, v254, v111
    v_mul_f32 v112, v254, v112
    v_mul_f32 v113, v254, v113
    v_mul_f32 v114, v254, v114
    v_mul_f32 v115, v254, v115
    v_mul_f32 v116, v254, v116
    v_mul_f32 v117, v254, v117
    v_mul_f32 v118, v254, v118
    v_mul_f32 v119, v254, v119
    v_mul_f32 v120, v254, v120
    v_mul_f32 v121, v254, v121
    v_mul_f32 v122, v254, v122
    v_mul_f32 v123, v254, v123
    v_mul_f32 v124, v254, v124
    v_mul_f32 v125, v254, v125
    v_mul_f32 v126, v254, v126
    v_mul_f32 v127, v254, v127
    s_branch L_STEP_C
L_STEPQ:
    v_add_u32 v8, s57, v241
    ds_read_b128 v[32:35], v8
    v_xor_b32 v9, 32, v8
    ds_read_b128 v[36:39], v9
    v_xor_b32 v10, 64, v8
    ds_read_b128 v[40:43], v10
    v_xor_b32 v11, 96, v8
    ds_read_b128 v[44:47], v11
    v_xor_b32 v12, 128, v8
    ds_read_b128 v[48:51], v12
    v_xor_b32 v13, 160, v8
    ds_read_b128 v[52:55], v13
    v_xor_b32 v14, 192, v8
    ds_read_b128 v[56:59], v14
    v_xor_b32 v15, 224, v8
    ds_read_b128 v[60:63], v15
    v_add_u32 v4, s57, v242
    v_xor_b32 v5, 64, v4
    v_xor_b32 v6, 128, v4
    v_xor_b32 v7, 192, v4
    s_add_u32 s57, s57, 32768
    s_cmp_ge_u32 s57, 98304
    s_cselect_b32 s57, 0, s57
    s_mov_b32 m0, s79
    s_waitcnt vmcnt(8)
    s_nop 0
    buffer_load_dwordx4 v236, s[24:27], s78 offen offset:0 nt lds
    s_waitcnt lgkmcnt(7)
    v_mfma_f32_32x32x16_bf16 v[16:31], v[32:35], v[200:203], 0
    ds_read_b64_tr_b16 v[32:33], v4 offset:0
    ds_read_b64_tr_b16 v[34:35], v4 offset:2048
    s_waitcnt lgkmcnt(8)
    v_mfma_f32_32x32x16_bf16 v[16:31], v[36:39], v[204:207], v[16:31]
    ds_read_b64_tr_b16 v[36:37], v4 offset:4096
    ds_read_b64_tr_b16 v[38:39], v4 offset:6144
    s_waitcnt vmcnt(8)
    buffer_load_dwordx4 v236, s[24:27], s78 offen offset:1024 nt lds
    s_waitcnt lgkmcnt(9)
    v_mfma_f32_32x32x16_bf16 v[16:31], v[40:43], v[208:211], v[16:31]
    ds_read_b64_tr_b16 v[40:41], v5 offset:0
    ds_read_b64_tr_b16 v[42:43], v5 offset:2048
    s_waitcnt lgkmcnt(10)
    v_mfma_f32_32x32x16_bf16 v[16:31], v[44:47], v[212:215], v[16:31]
    ds_read_b64_tr_b16 v[44:45], v5 offset:4096
    ds_read_b64_tr_b16 v[46:47], v5 offset:6144
    s_waitcnt vmcnt(8)
    buffer_load_dwordx4 v236, s[24:27], s78 offen offset:2048 nt lds
    s_waitcnt lgkmcnt(11)
    v_mfma_f32_32x32x16_bf16 v[16:31], v[48:51], v[216:219], v[16:31]
    ds_read_b64_tr_b16 v[48:49], v6 offset:0
    ds_read_b64_tr_b16 v[50:51], v6 offset:2048
    s_waitcnt lgkmcnt(12)
    v_mfma_f32_32x32x16_bf16 v[16:31], v[52:55], v[220:223], v[16:31]
    ds_read_b64_tr_b16 v[52:53], v6 offset:4096
    ds_read_b64_tr_b16 v[54:55], v6 offset:6144
    s_waitcnt vmcnt(8)
    buffer_load_dwordx4 v236, s[24:27], s78 offen offset:3072 nt lds
    s_waitcnt lgkmcnt(13)
    v_mfma_f32_32x32x16_bf16 v[16:31], v[56:59], v[224:227], v[16:31]
    ds_read_b64_tr_b16 v[56:57], v7 offset:0
    ds_read_b64_tr_b16 v[58:59], v7 offset:2048
    s_waitcnt lgkmcnt(13)
    v_mfma_f32_32x32x16_bf16 v[16:31], v[60:63], v[228:231], v[16:31]
    ds_read_b64_tr_b16 v[60:61], v7 offset:4096
    ds_read_b64_tr_b16 v[62:63], v7 offset:6144
    s_mov_b32 m0, s56
    s_waitcnt lgkmcnt(0)
    s_barrier
    s_waitcnt vmcnt(8)
    buffer_load_dwordx4 v232, s[20:23], s55 offen offset:0 nt lds
    s_nop 4
    v_max3_f32 v1, v16, v17, v18
    v_max3_f32 v2, v19, v20, v21
    v_max3_f32 v1, v1, v22, v23
    v_max3_f32 v2, v2, v24, v25
    v_max3_f32 v1, v1, v26, v27
    v_max3_f32 v2, v2, v28, v29
    v_max3_f32 v1, v1, v30, v31
    v_max_f32 v1, v1, v2
    v_fma_f32 v2, v1, s60, -v252
    v_cmp_nge_f32 vcc, s70, v2
    s_waitcnt vmcnt(8)
    buffer_load_dwordx4 v233, s[20:23], s55 offen offset:1024 nt lds
    s_cbranch_vccnz L_STEPQ_R
L_STEPQ_C:
    v_fma_f32 v16, v16, s60, -v252
    v_fma_f32 v17, v17, s60, -v252
    v_fma_f32 v18, v18, s60, -v252
    v_fma_f32 v19, v19, s60, -v252
    v_fma_f32 v20, v20, s60, -v252
    v_fma_f32 v21, v21, s60, -v252
    v_fma_f32 v22, v22, s60, -v252
    v_fma_f32 v23, v23, s60, -v252
    v_exp_f32 v16, v16
    v_exp_f32 v17, v17
    v_exp_f32 v18, v18
    v_exp_f32 v19, v19
    s_waitcnt vmcnt(8)
    buffer_load_dwordx4 v234, s[20:23], s55 offen offset:2048 nt lds
    v_exp_f32 v20, v20
    v_exp_f32 v21, v21
    v_exp_f32 v22, v22
    v_exp_f32 v23, v23
    v_fma_f32 v24, v24, s60, -v252
    v_fma_f32 v25, v25, s60, -v252
    v_fma_f32 v26, v26, s60, -v252
    v_fma_f32 v27, v27, s60, -v252
    v_cvt_pk_bf16_f32 v8, v16, v17
    v_cvt_pk_bf16_f32 v9, v18, v19
    v_cvt_pk_bf16_f32 v10, v20, v21
    v_cvt_pk_bf16_f32 v11, v22, v23
    s_waitcnt vmcnt(8)
    buffer_load_dwordx4 v235, s[20:23], s55 offen offset:3072 nt lds
    v_fma_f32 v28, v28, s60, -v252
    v_fma_f32 v29, v29, s60, -v252
    v_fma_f32 v30, v30, s60, -v252
    v_fma_f32 v31, v31, s60, -v252
    v_mfma_f32_32x32x16_bf16 v[64:79], v[32:35], v[8:11], v[64:79]
    v_exp_f32 v24, v24
    v_exp_f32 v25, v25
    v_exp_f32 v26, v26
    v_mfma_f32_32x32x16_bf16 v[80:95], v[40:43], v[8:11], v[80:95]
    v_exp_f32 v27, v27
    v_exp_f32 v28, v28
    v_exp_f32 v29, v29
    v_mfma_f32_32x32x16_bf16 v[96:111], v[48:51], v[8:11], v[96:111]
    s_waitcnt vmcnt(8)
    s_mov_b32 m0, s75
    s_mov_b32 s76, s74
    buffer_load_dwordx4 v237, s[28:31], s76 offen offset:0 nt lds
    v_exp_f32 v30, v30
    v_exp_f32 v31, v31
    v_add_f32 v1, v16, v17
    v_mfma_f32_32x32x16_bf16 v[112:127], v[56:59], v[8:11], v[112:127]
    v_cvt_pk_bf16_f32 v12, v24, v25
    v_cvt_pk_bf16_f32 v13, v26, v27
    v_cvt_pk_bf16_f32 v14, v28, v29
    v_cvt_pk_bf16_f32 v15, v30, v31
    v_add_f32 v2, v18, v19
    s_waitcnt vmcnt(8)
    s_add_u32 s76, s76, 64512
    buffer_load_dwordx4 v237, s[28:31], s76 offen offset:1024 nt lds
    v_add_f32 v1, v1, v20
    v_mfma_f32_32x32x16_bf16 v[64:79], v[36:39], v[12:15], v[64:79]
    v_add_f32 v2, v2, v21
    v_add_f32 v1, v1, v22
    v_add_f32 v2, v2, v23
    v_add_f32 v1, v1, v24
    v_add_f32 v2, v2, v25
    v_mfma_f32_32x32x16_bf16 v[80:95], v[44:47], v[12:15], v[80:95]
    s_waitcnt vmcnt(8)
    s_add_u32 s76, s76, 64512
    buffer_load_dwordx4 v237, s[28:31], s76 offen offset:2048 nt lds
    v_add_f32 v1, v1, v26
    v_add_f32 v2, v2, v27
    v_add_f32 v1, v1, v28
    v_add_f32 v2, v2, v29
    v_mfma_f32_32x32x16_bf16 v[96:111], v[52:55], v[12:15], v[96:111]
    s_waitcnt vmcnt(8)
    s_add_u32 s76, s76, 64512
    buffer_load_dwordx4 v237, s[28:31], s76 offen offset:3072 nt lds
    s_add_u32 s74, s74, 262144
    s_sub_u32 s75, s77, s75
    v_add_f32 v1, v1, v30
    v_add_f32 v2, v2, v31
    v_add_f32 v253, v253, v1
    v_add_f32 v253, v253, v2
    v_mfma_f32_32x32x16_bf16 v[112:127], v[60:63], v[12:15], v[112:127]
    s_mov_b32 s78, s55
    s_add_u32 s79, s56, 16384
    s_add_u32 s55, s55, 16384
    s_add_u32 s56, s56, 32768
    s_cmp_ge_u32 s56, 98304
    s_cselect_b32 s64, 98304, 0
    s_sub_u32 s56, s56, s64
    s_setpc_b64 s[58:59]
L_STEPQ_R:
    v_mov_b32 v2, v1
    s_nop 1
    v_permlane32_swap_b32 v1, v2
    v_max_f32 v1, v1, v2
    v_mul_f32 v1, s60, v1
    v_max_f32 v1, v1, v252
    v_sub_f32 v254, v252, v1
    v_mov_b32 v252, v1
    v_exp_f32 v254, v254
    s_nop 0
    v_mul_f32 v253, v254, v253
    v_mul_f32 v64, v254, v64
    v_mul_f32 v65, v254, v65
    v_mul_f32 v66, v254, v66
    v_mul_f32 v67, v254, v67
    v_mul_f32 v68, v254, v68
    v_mul_f32 v69, v254, v69
    v_mul_f32 v70, v254, v70
    v_mul_f32 v71, v254, v71
    v_mul_f32 v72, v254, v72
    v_mul_f32 v73, v254, v73
    v_mul_f32 v74, v254, v74
    v_mul_f32 v75, v254, v75
    v_mul_f32 v76, v254, v76
    v_mul_f32 v77, v254, v77
    v_mul_f32 v78, v254, v78
    v_mul_f32 v79, v254, v79
    v_mul_f32 v80, v254, v80
    v_mul_f32 v81, v254, v81
    v_mul_f32 v82, v254, v82
    v_mul_f32 v83, v254, v83
    v_mul_f32 v84, v254, v84
    v_mul_f32 v85, v254, v85
    v_mul_f32 v86, v254, v86
    v_mul_f32 v87, v254, v87
    v_mul_f32 v88, v254, v88
    v_mul_f32 v89, v254, v89
    v_mul_f32 v90, v254, v90
    v_mul_f32 v91, v254, v91
    v_mul_f32 v92, v254, v92
    v_mul_f32 v93, v254, v93
    v_mul_f32 v94, v254, v94
    v_mul_f32 v95, v254, v95
    v_mul_f32 v96, v254, v96
    v_mul_f32 v97, v254, v97
    v_mul_f32 v98, v254, v98
    v_mul_f32 v99, v254, v99
    v_mul_f32 v100, v254, v100
    v_mul_f32 v101, v254, v101
    v_mul_f32 v102, v254, v102
    v_mul_f32 v103, v254, v103
    v_mul_f32 v104, v254, v104
    v_mul_f32 v105, v254, v105
    v_mul_f32 v106, v254, v106
    v_mul_f32 v107, v254, v107
    v_mul_f32 v108, v254, v108
    v_mul_f32 v109, v254, v109
    v_mul_f32 v110, v254, v110
    v_mul_f32 v111, v254, v111
    v_mul_f32 v112, v254, v112
    v_mul_f32 v113, v254, v113
    v_mul_f32 v114, v254, v114
    v_mul_f32 v115, v254, v115
    v_mul_f32 v116, v254, v116
    v_mul_f32 v117, v254, v117
    v_mul_f32 v118, v254, v118
    v_mul_f32 v119, v254, v119
    v_mul_f32 v120, v254, v120
    v_mul_f32 v121, v254, v121
    v_mul_f32 v122, v254, v122
    v_mul_f32 v123, v254, v123
    v_mul_f32 v124, v254, v124
    v_mul_f32 v125, v254, v125
    v_mul_f32 v126, v254, v126
    v_mul_f32 v127, v254, v127
    s_branch L_STEPQ_C
L_STEPO:
    v_add_u32 v8, s57, v241
    ds_read_b128 v[32:35], v8
    v_xor_b32 v9, 32, v8
    ds_read_b128 v[36:39], v9
    v_xor_b32 v10, 64, v8
    ds_read_b128 v[40:43], v10
    v_xor_b32 v11, 96, v8
    ds_read_b128 v[44:47], v11
    v_xor_b32 v12, 128, v8
    ds_read_b128 v[48:51], v12
    v_xor_b32 v13, 160, v8
    ds_read_b128 v[52:55], v13
    v_xor_b32 v14, 192, v8
    ds_read_b128 v[56:59], v14
    v_xor_b32 v15, 224, v8
    ds_read_b128 v[60:63], v15
    v_add_u32 v4, s57, v242
    v_xor_b32 v5, 64, v4
    v_xor_b32 v6, 128, v4
    v_xor_b32 v7, 192, v4
    s_add_u32 s57, s57, 32768
    s_cmp_ge_u32 s57, 98304
    s_cselect_b32 s57, 0, s57
    s_mov_b32 m0, s79
    s_waitcnt vmcnt(8)
    s_nop 0
    buffer_load_dwordx4 v236, s[24:27], s78 offen offset:0 nt lds
    s_waitcnt lgkmcnt(7)
    v_mfma_f32_32x32x16_bf16 v[16:31], v[32:35], v[200:203], 0
    ds_read_b64_tr_b16 v[32:33], v4 offset:0
    ds_read_b64_tr_b16 v[34:35], v4 offset:2048
    s_waitcnt lgkmcnt(8)
    v_mfma_f32_32x32x16_bf16 v[16:31], v[36:39], v[204:207], v[16:31]
    ds_read_b64_tr_b16 v[36:37], v4 offset:4096
    ds_read_b64_tr_b16 v[38:39], v4 offset:6144
    s_waitcnt vmcnt(8)
    buffer_load_dwordx4 v236, s[24:27], s78 offen offset:1024 nt lds
    s_waitcnt lgkmcnt(9)
    v_mfma_f32_32x32x16_bf16 v[16:31], v[40:43], v[208:211], v[16:31]
    ds_read_b64_tr_b16 v[40:41], v5 offset:0
    ds_read_b64_tr_b16 v[42:43], v5 offset:2048
    s_waitcnt lgkmcnt(10)
    v_mfma_f32_32x32x16_bf16 v[16:31], v[44:47], v[212:215], v[16:31]
    ds_read_b64_tr_b16 v[44:45], v5 offset:4096
    ds_read_b64_tr_b16 v[46:47], v5 offset:6144
    s_waitcnt vmcnt(8)
    buffer_load_dwordx4 v236, s[24:27], s78 offen offset:2048 nt lds
    s_waitcnt lgkmcnt(11)
    v_mfma_f32_32x32x16_bf16 v[16:31], v[48:51], v[216:219], v[16:31]
    ds_read_b64_tr_b16 v[48:49], v6 offset:0
    ds_read_b64_tr_b16 v[50:51], v6 offset:2048
    s_waitcnt lgkmcnt(12)
    v_mfma_f32_32x32x16_bf16 v[16:31], v[52:55], v[220:223], v[16:31]
    ds_read_b64_tr_b16 v[52:53], v6 offset:4096
    ds_read_b64_tr_b16 v[54:55], v6 offset:6144
    s_waitcnt vmcnt(8)
    buffer_load_dwordx4 v236, s[24:27], s78 offen offset:3072 nt lds
    s_waitcnt lgkmcnt(13)
    v_mfma_f32_32x32x16_bf16 v[16:31], v[56:59], v[224:227], v[16:31]
    ds_read_b64_tr_b16 v[56:57], v7 offset:0
    ds_read_b64_tr_b16 v[58:59], v7 offset:2048
    s_waitcnt lgkmcnt(13)
    v_mfma_f32_32x32x16_bf16 v[16:31], v[60:63], v[228:231], v[16:31]
    ds_read_b64_tr_b16 v[60:61], v7 offset:4096
    ds_read_b64_tr_b16 v[62:63], v7 offset:6144
    s_mov_b32 m0, s56
    s_waitcnt lgkmcnt(0)
    s_barrier
    s_waitcnt vmcnt(8)
    buffer_load_dwordx4 v232, s[20:23], s55 offen offset:0 nt lds
    s_nop 4
    v_max3_f32 v1, v16, v17, v18
    v_max3_f32 v2, v19, v20, v21
    v_max3_f32 v1, v1, v22, v23
    v_max3_f32 v2, v2, v24, v25
    v_max3_f32 v1, v1, v26, v27
    v_max3_f32 v2, v2, v28, v29
    v_max3_f32 v1, v1, v30, v31
    v_max_f32 v1, v1, v2
    v_fma_f32 v2, v1, s60, -v252
    v_cmp_nge_f32 vcc, s70, v2
    s_waitcnt vmcnt(8)
    buffer_load_dwordx4 v233, s[20:23], s55 offen offset:1024 nt lds
    s_cbranch_vccnz L_STEPO_R
L_STEPO_C:
    v_fma_f32 v16, v16, s60, -v252
    v_fma_f32 v17, v17, s60, -v252
    v_fma_f32 v18, v18, s60, -v252
    v_fma_f32 v19, v19, s60, -v252
    v_fma_f32 v20, v20, s60, -v252
    v_fma_f32 v21, v21, s60, -v252
    v_fma_f32 v22, v22, s60, -v252
    v_fma_f32 v23, v23, s60, -v252
    v_exp_f32 v16, v16
    v_exp_f32 v17, v17
    v_exp_f32 v18, v18
    v_exp_f32 v19, v19
    s_waitcnt vmcnt(8)
    buffer_load_dwordx4 v234, s[20:23], s55 offen offset:2048 nt lds
    v_exp_f32 v20, v20
    v_exp_f32 v21, v21
    v_exp_f32 v22, v22
    v_exp_f32 v23, v23
    v_fma_f32 v24, v24, s60, -v252
    v_fma_f32 v25, v25, s60, -v252
    v_fma_f32 v26, v26, s60, -v252
    v_fma_f32 v27, v27, s60, -v252
    v_cvt_pk_bf16_f32 v8, v16, v17
    v_cvt_pk_bf16_f32 v9, v18, v19
    v_cvt_pk_bf16_f32 v10, v20, v21
    v_cvt_pk_bf16_f32 v11, v22, v23
    s_waitcnt vmcnt(8)
    buffer_load_dwordx4 v235, s[20:23], s55 offen offset:3072 nt lds
    v_fma_f32 v28, v28, s60, -v252
    v_fma_f32 v29, v29, s60, -v252
    v_fma_f32 v30, v30, s60, -v252
    v_fma_f32 v31, v31, s60, -v252
    v_mfma_f32_32x32x16_bf16 v[64:79], v[32:35], v[8:11], v[64:79]
    v_exp_f32 v24, v24
    v_exp_f32 v25, v25
    v_exp_f32 v26, v26
    v_mfma_f32_32x32x16_bf16 v[80:95], v[40:43], v[8:11], v[80:95]
    v_exp_f32 v27, v27
    v_exp_f32 v28, v28
    v_exp_f32 v29, v29
    v_mfma_f32_32x32x16_bf16 v[96:111], v[48:51], v[8:11], v[96:111]
    s_waitcnt vmcnt(8)
    s_mov_b32 m0, s75
    s_nop 0
    buffer_load_dwordx4 v238, s[32:35], s74 offen offset:0 nt lds
    v_exp_f32 v30, v30
    v_exp_f32 v31, v31
    v_add_f32 v1, v16, v17
    v_mfma_f32_32x32x16_bf16 v[112:127], v[56:59], v[8:11], v[112:127]
    v_cvt_pk_bf16_f32 v12, v24, v25
    v_cvt_pk_bf16_f32 v13, v26, v27
    v_cvt_pk_bf16_f32 v14, v28, v29
    v_cvt_pk_bf16_f32 v15, v30, v31
    v_add_f32 v2, v18, v19
    s_waitcnt vmcnt(8)
    buffer_load_dwordx4 v238, s[32:35], s74 offen offset:1024 nt lds
    v_add_f32 v1, v1, v20
    v_mfma_f32_32x32x16_bf16 v[64:79], v[36:39], v[12:15], v[64:79]
    v_add_f32 v2, v2, v21
    v_add_f32 v1, v1, v22
    v_add_f32 v2, v2, v23
    v_add_f32 v1, v1, v24
    v_add_f32 v2, v2, v25
    v_mfma_f32_32x32x16_bf16 v[80:95], v[44:47], v[12:15], v[80:95]
    s_waitcnt vmcnt(8)
    buffer_load_dwordx4 v240, s[32:35], s74 offen offset:2048 nt lds
    v_add_f32 v1, v1, v26
    v_add_f32 v2, v2, v27
    v_add_f32 v1, v1, v28
    v_add_f32 v2, v2, v29
    v_mfma_f32_32x32x16_bf16 v[96:111], v[52:55], v[12:15], v[96:111]
    s_waitcnt vmcnt(8)
    buffer_load_dwordx4 v239, s[32:35], s74 offen offset:3072 nt lds
    v_add_f32 v1, v1, v30
    v_add_f32 v2, v2, v31
    v_add_f32 v253, v253, v1
    v_add_f32 v253, v253, v2
    v_mfma_f32_32x32x16_bf16 v[112:127], v[60:63], v[12:15], v[112:127]
    s_waitcnt vmcnt(8)
    s_add_u32 m0, s75, 4096
    s_add_u32 s76, s74, 4096
    s_mov_b64 exec, 0xffffffff
    buffer_load_dwordx4 v239, s[32:35], s76 offen nt lds
    s_mov_b64 exec, -1
    s_add_u32 s74, s74, 18432
    s_sub_u32 s75, s77, s75
    s_mov_b32 s78, s55
    s_add_u32 s79, s56, 16384
    s_add_u32 s55, s55, 16384
    s_add_u32 s56, s56, 32768
    s_cmp_ge_u32 s56, 98304
    s_cselect_b32 s64, 98304, 0
    s_sub_u32 s56, s56, s64
    s_setpc_b64 s[58:59]
L_STEPO_R:
    v_mov_b32 v2, v1
    s_nop 1
    v_permlane32_swap_b32 v1, v2
    v_max_f32 v1, v1, v2
    v_mul_f32 v1, s60, v1
    v_max_f32 v1, v1, v252
    v_sub_f32 v254, v252, v1
    v_mov_b32 v252, v1
    v_exp_f32 v254, v254
    s_nop 0
    v_mul_f32 v253, v254, v253
    v_mul_f32 v64, v254, v64
    v_mul_f32 v65, v254, v65
    v_mul_f32 v66, v254, v66
    v_mul_f32 v67, v254, v67
    v_mul_f32 v68, v254, v68
    v_mul_f32 v69, v254, v69
    v_mul_f32 v70, v254, v70
    v_mul_f32 v71, v254, v71
    v_mul_f32 v72, v254, v72
    v_mul_f32 v73, v254, v73
    v_mul_f32 v74, v254, v74
    v_mul_f32 v75, v254, v75
    v_mul_f32 v76, v254, v76
    v_mul_f32 v77, v254, v77
    v_mul_f32 v78, v254, v78
    v_mul_f32 v79, v254, v79
    v_mul_f32 v80, v254, v80
    v_mul_f32 v81, v254, v81
    v_mul_f32 v82, v254, v82
    v_mul_f32 v83, v254, v83
    v_mul_f32 v84, v254, v84
    v_mul_f32 v85, v254, v85
    v_mul_f32 v86, v254, v86
    v_mul_f32 v87, v254, v87
    v_mul_f32 v88, v254, v88
    v_mul_f32 v89, v254, v89
    v_mul_f32 v90, v254, v90
    v_mul_f32 v91, v254, v91
    v_mul_f32 v92, v254, v92
    v_mul_f32 v93, v254, v93
    v_mul_f32 v94, v254, v94
    v_mul_f32 v95, v254, v95
    v_mul_f32 v96, v254, v96
    v_mul_f32 v97, v254, v97
    v_mul_f32 v98, v254, v98
    v_mul_f32 v99, v254, v99
    v_mul_f32 v100, v254, v100
    v_mul_f32 v101, v254, v101
    v_mul_f32 v102, v254, v102
    v_mul_f32 v103, v254, v103
    v_mul_f32 v104, v254, v104
    v_mul_f32 v105, v254, v105
    v_mul_f32 v106, v254, v106
    v_mul_f32 v107, v254, v107
    v_mul_f32 v108, v254, v108
    v_mul_f32 v109, v254, v109
    v_mul_f32 v110, v254, v110
    v_mul_f32 v111, v254, v111
    v_mul_f32 v112, v254, v112
    v_mul_f32 v113, v254, v113
    v_mul_f32 v114, v254, v114
    v_mul_f32 v115, v254, v115
    v_mul_f32 v116, v254, v116
    v_mul_f32 v117, v254, v117
    v_mul_f32 v118, v254, v118
    v_mul_f32 v119, v254, v119
    v_mul_f32 v120, v254, v120
    v_mul_f32 v121, v254, v121
    v_mul_f32 v122, v254, v122
    v_mul_f32 v123, v254, v123
    v_mul_f32 v124, v254, v124
    v_mul_f32 v125, v254, v125
    v_mul_f32 v126, v254, v126
    v_mul_f32 v127, v254, v127
    s_branch L_STEPO_C
L_STEPQ_NV:
    v_add_u32 v8, s57, v241
    ds_read_b128 v[32:35], v8
    v_xor_b32 v9, 32, v8
    ds_read_b128 v[36:39], v9
    v_xor_b32 v10, 64, v8
    ds_read_b128 v[40:43], v10
    v_xor_b32 v11, 96, v8
    ds_read_b128 v[44:47], v11
    v_xor_b32 v12, 128, v8
    ds_read_b128 v[48:51], v12
    v_xor_b32 v13, 160, v8
    ds_read_b128 v[52:55], v13
    v_xor_b32 v14, 192, v8
    ds_read_b128 v[56:59], v14
    v_xor_b32 v15, 224, v8
    ds_read_b128 v[60:63], v15
    v_add_u32 v4, s57, v242
    v_xor_b32 v5, 64, v4
    v_xor_b32 v6, 128, v4
    v_xor_b32 v7, 192, v4
    s_add_u32 s57, s57, 32768
    s_cmp_ge_u32 s57, 98304
    s_cselect_b32 s57, 0, s57
    s_waitcnt lgkmcnt(7)
    v_mfma_f32_32x32x16_bf16 v[16:31], v[32:35], v[200:203], 0
    ds_read_b64_tr_b16 v[32:33], v4 offset:0
    ds_read_b64_tr_b16 v[34:35], v4 offset:2048
    s_waitcnt lgkmcnt(8)
    v_mfma_f32_32x32x16_bf16 v[16:31], v[36:39], v[204:207], v[16:31]
    ds_read_b64_tr_b16 v[36:37], v4 offset:4096
    ds_read_b64_tr_b16 v[38:39], v4 offset:6144
    s_waitcnt lgkmcnt(9)
    v_mfma_f32_32x32x16_bf16 v[16:31], v[40:43], v[208:211], v[16:31]
    ds_read_b64_tr_b16 v[40:41], v5 offset:0
    ds_read_b64_tr_b16 v[42:43], v5 offset:2048
    s_waitcnt lgkmcnt(10)
    v_mfma_f32_32x32x16_bf16 v[16:31], v[44:47], v[212:215], v[16:31]
    ds_read_b64_tr_b16 v[44:45], v5 offset:4096
    ds_read_b64_tr_b16 v[46:47], v5 offset:6144
    s_waitcnt lgkmcnt(11)
    v_mfma_f32_32x32x16_bf16 v[16:31], v[48:51], v[216:219], v[16:31]
    ds_read_b64_tr_b16 v[48:49], v6 offset:0
    ds_read_b64_tr_b16 v[50:51], v6 offset:2048
    s_waitcnt lgkmcnt(12)
    v_mfma_f32_32x32x16_bf16 v[16:31], v[52:55], v[220:223], v[16:31]
    ds_read_b64_tr_b16 v[52:53], v6 offset:4096
    ds_read_b64_tr_b16 v[54:55], v6 offset:6144
    s_waitcnt lgkmcnt(13)
    v_mfma_f32_32x32x16_bf16 v[16:31], v[56:59], v[224:227], v[16:31]
    ds_read_b64_tr_b16 v[56:57], v7 offset:0
    ds_read_b64_tr_b16 v[58:59], v7 offset:2048
    s_waitcnt lgkmcnt(13)
    v_mfma_f32_32x32x16_bf16 v[16:31], v[60:63], v[228:231], v[16:31]
    ds_read_b64_tr_b16 v[60:61], v7 offset:4096
    ds_read_b64_tr_b16 v[62:63], v7 offset:6144
    s_mov_b32 m0, s56
    s_waitcnt lgkmcnt(0)
    s_barrier
    s_waitcnt vmcnt(8)
    buffer_load_dwordx4 v232, s[20:23], s55 offen offset:0 nt lds
    s_nop 4
    v_max3_f32 v1, v16, v17, v18
    v_max3_f32 v2, v19, v20, v21
    v_max3_f32 v1, v1, v22, v23
    v_max3_f32 v2, v2, v24, v25
    v_max3_f32 v1, v1, v26, v27
    v_max3_f32 v2, v2, v28, v29
    v_max3_f32 v1, v1, v30, v31
    v_max_f32 v1, v1, v2
    v_fma_f32 v2, v1, s60, -v252
    v_cmp_nge_f32 vcc, s70, v2
    s_waitcnt vmcnt(8)
    buffer_load_dwordx4 v233, s[20:23], s55 offen offset:1024 nt lds
    s_cbranch_vccnz L_STEPQ_NV_R
L_STEPQ_NV_C:
    v_fma_f32 v16, v16, s60, -v252
    v_fma_f32 v17, v17, s60, -v252
    v_fma_f32 v18, v18, s60, -v252
    v_fma_f32 v19, v19, s60, -v252
    v_fma_f32 v20, v20, s60, -v252
    v_fma_f32 v21, v21, s60, -v252
    v_fma_f32 v22, v22, s60, -v252
    v_fma_f32 v23, v23, s60, -v252
    v_exp_f32 v16, v16
    v_exp_f32 v17, v17
    v_exp_f32 v18, v18
    v_exp_f32 v19, v19
    s_waitcnt vmcnt(8)
    buffer_load_dwordx4 v234, s[20:23], s55 offen offset:2048 nt lds
    v_exp_f32 v20, v20
    v_exp_f32 v21, v21
    v_exp_f32 v22, v22
    v_exp_f32 v23, v23
    v_fma_f32 v24, v24, s60, -v252
    v_fma_f32 v25, v25, s60, -v252
    v_fma_f32 v26, v26, s60, -v252
    v_fma_f32 v27, v27, s60, -v252
    v_cvt_pk_bf16_f32 v8, v16, v17
    v_cvt_pk_bf16_f32 v9, v18, v19
    v_cvt_pk_bf16_f32 v10, v20, v21
    v_cvt_pk_bf16_f32 v11, v22, v23
    s_waitcnt vmcnt(8)
    buffer_load_dwordx4 v235, s[20:23], s55 offen offset:3072 nt lds
    v_fma_f32 v28, v28, s60, -v252
    v_fma_f32 v29, v29, s60, -v252
    v_fma_f32 v30, v30, s60, -v252
    v_fma_f32 v31, v31, s60, -v252
    v_mfma_f32_32x32x16_bf16 v[64:79], v[32:35], v[8:11], v[64:79]
    v_exp_f32 v24, v24
    v_exp_f32 v25, v25
    v_exp_f32 v26, v26
    v_mfma_f32_32x32x16_bf16 v[80:95], v[40:43], v[8:11], v[80:95]
    v_exp_f32 v27, v27
    v_exp_f32 v28, v28
    v_exp_f32 v29, v29
    v_mfma_f32_32x32x16_bf16 v[96:111], v[48:51], v[8:11], v[96:111]
    s_waitcnt vmcnt(8)
    s_mov_b32 m0, s75
    s_mov_b32 s76, s74
    buffer_load_dwordx4 v237, s[28:31], s76 offen offset:0 nt lds
    v_exp_f32 v30, v30
    v_exp_f32 v31, v31
    v_add_f32 v1, v16, v17
    v_mfma_f32_32x32x16_bf16 v[112:127], v[56:59], v[8:11], v[112:127]
    v_cvt_pk_bf16_f32 v12, v24, v25
    v_cvt_pk_bf16_f32 v13, v26, v27
    v_cvt_pk_bf16_f32 v14, v28, v29
    v_cvt_pk_bf16_f32 v15, v30, v31
    v_add_f32 v2, v18, v19
    s_waitcnt vmcnt(8)
    s_add_u32 s76, s76, 64512
    buffer_load_dwordx4 v237, s[28:31], s76 offen offset:1024 nt lds
    v_add_f32 v1, v1, v20
    v_mfma_f32_32x32x16_bf16 v[64:79], v[36:39], v[12:15], v[64:79]
    v_add_f32 v2, v2, v21
    v_add_f32 v1, v1, v22
    v_add_f32 v2, v2, v23
    v_add_f32 v1, v1, v24
    v_add_f32 v2, v2, v25
    v_mfma_f32_32x32x16_bf16 v[80:95], v[44:47], v[12:15], v[80:95]
    s_waitcnt vmcnt(8)
    s_add_u32 s76, s76, 64512
    buffer_load_dwordx4 v237, s[28:31], s76 offen offset:2048 nt lds
    v_add_f32 v1, v1, v26
    v_add_f32 v2, v2, v27
    v_add_f32 v1, v1, v28
    v_add_f32 v2, v2, v29
    v_mfma_f32_32x32x16_bf16 v[96:111], v[52:55], v[12:15], v[96:111]
    s_waitcnt vmcnt(8)
    s_add_u32 s76, s76, 64512
    buffer_load_dwordx4 v237, s[28:31], s76 offen offset:3072 nt lds
    s_add_u32 s74, s74, 262144
    s_sub_u32 s75, s77, s75
    v_add_f32 v1, v1, v30
    v_add_f32 v2, v2, v31
    v_add_f32 v253, v253, v1
    v_add_f32 v253, v253, v2
    v_mfma_f32_32x32x16_bf16 v[112:127], v[60:63], v[12:15], v[112:127]
    s_mov_b32 s78, s55
    s_add_u32 s79, s56, 16384
    s_add_u32 s55, s55, 16384
    s_add_u32 s56, s56, 32768
    s_cmp_ge_u32 s56, 98304
    s_cselect_b32 s64, 98304, 0
    s_sub_u32 s56, s56, s64
    s_setpc_b64 s[58:59]
L_STEPQ_NV_R:
    v_mov_b32 v2, v1
    s_nop 1
    v_permlane32_swap_b32 v1, v2
    v_max_f32 v1, v1, v2
    v_mul_f32 v1, s60, v1
    v_max_f32 v1, v1, v252
    v_sub_f32 v254, v252, v1
    v_mov_b32 v252, v1
    v_exp_f32 v254, v254
    s_nop 0
    v_mul_f32 v253, v254, v253
    v_mul_f32 v64, v254, v64
    v_mul_f32 v65, v254, v65
    v_mul_f32 v66, v254, v66
    v_mul_f32 v67, v254, v67
    v_mul_f32 v68, v254, v68
    v_mul_f32 v69, v254, v69
    v_mul_f32 v70, v254, v70
    v_mul_f32 v71, v254, v71
    v_mul_f32 v72, v254, v72
    v_mul_f32 v73, v254, v73
    v_mul_f32 v74, v254, v74
    v_mul_f32 v75, v254, v75
    v_mul_f32 v76, v254, v76
    v_mul_f32 v77, v254, v77
    v_mul_f32 v78, v254, v78
    v_mul_f32 v79, v254, v79
    v_mul_f32 v80, v254, v80
    v_mul_f32 v81, v254, v81
    v_mul_f32 v82, v254, v82
    v_mul_f32 v83, v254, v83
    v_mul_f32 v84, v254, v84
    v_mul_f32 v85, v254, v85
    v_mul_f32 v86, v254, v86
    v_mul_f32 v87, v254, v87
    v_mul_f32 v88, v254, v88
    v_mul_f32 v89, v254, v89
    v_mul_f32 v90, v254, v90
    v_mul_f32 v91, v254, v91
    v_mul_f32 v92, v254, v92
    v_mul_f32 v93, v254, v93
    v_mul_f32 v94, v254, v94
    v_mul_f32 v95, v254, v95
    v_mul_f32 v96, v254, v96
    v_mul_f32 v97, v254, v97
    v_mul_f32 v98, v254, v98
    v_mul_f32 v99, v254, v99
    v_mul_f32 v100, v254, v100
    v_mul_f32 v101, v254, v101
    v_mul_f32 v102, v254, v102
    v_mul_f32 v103, v254, v103
    v_mul_f32 v104, v254, v104
    v_mul_f32 v105, v254, v105
    v_mul_f32 v106, v254, v106
    v_mul_f32 v107, v254, v107
    v_mul_f32 v108, v254, v108
    v_mul_f32 v109, v254, v109
    v_mul_f32 v110, v254, v110
    v_mul_f32 v111, v254, v111
    v_mul_f32 v112, v254, v112
    v_mul_f32 v113, v254, v113
    v_mul_f32 v114, v254, v114
    v_mul_f32 v115, v254, v115
    v_mul_f32 v116, v254, v116
    v_mul_f32 v117, v254, v117
    v_mul_f32 v118, v254, v118
    v_mul_f32 v119, v254, v119
    v_mul_f32 v120, v254, v120
    v_mul_f32 v121, v254, v121
    v_mul_f32 v122, v254, v122
    v_mul_f32 v123, v254, v123
    v_mul_f32 v124, v254, v124
    v_mul_f32 v125, v254, v125
    v_mul_f32 v126, v254, v126
    v_mul_f32 v127, v254, v127
    s_branch L_STEPQ_NV_C
L_A:
    v_add_u32 v4, s57, v242
    v_xor_b32 v5, 64, v4
    v_xor_b32 v6, 128, v4
    v_xor_b32 v7, 192, v4
    s_add_u32 s57, s57, 32768
    s_cmp_ge_u32 s57, 98304
    s_cselect_b32 s57, 0, s57
    s_mov_b32 m0, s79
    s_nop 0
    buffer_load_dwordx4 v236, s[24:27], s78 offen offset:0 nt lds
    s_waitcnt lgkmcnt(7)
    v_mfma_f32_32x32x16_bf16 v[16:31], v[32:35], v[200:203], 0
    ds_read_b64_tr_b16 v[32:33], v4 offset:0
    ds_read_b64_tr_b16 v[34:35], v4 offset:2048
    s_waitcnt lgkmcnt(8)
    v_mfma_f32_32x32x16_bf16 v[16:31], v[40:43], v[208:211], v[16:31]
    ds_read_b64_tr_b16 v[40:41], v5 offset:0
    ds_read_b64_tr_b16 v[42:43], v5 offset:2048
    buffer_load_dwordx4 v236, s[24:27], s78 offen offset:1024 nt lds
    s_waitcnt lgkmcnt(9)
    v_mfma_f32_32x32x16_bf16 v[16:31], v[48:51], v[216:219], v[16:31]
    ds_read_b64_tr_b16 v[48:49], v6 offset:0
    ds_read_b64_tr_b16 v[50:51], v6 offset:2048
    s_waitcnt lgkmcnt(10)
    v_mfma_f32_32x32x16_bf16 v[16:31], v[56:59], v[224:227], v[16:31]
    ds_read_b64_tr_b16 v[56:57], v7 offset:0
    ds_read_b64_tr_b16 v[58:59], v7 offset:2048
    buffer_load_dwordx4 v236, s[24:27], s78 offen offset:2048 nt lds
    s_waitcnt lgkmcnt(11)
    v_mfma_f32_32x32x16_bf16 v[16:31], v[36:39], v[204:207], v[16:31]
    ds_read_b64_tr_b16 v[36:37], v4 offset:4096
    ds_read_b64_tr_b16 v[38:39], v4 offset:6144
    s_waitcnt lgkmcnt(12)
    v_mfma_f32_32x32x16_bf16 v[16:31], v[44:47], v[212:215], v[16:31]
    ds_read_b64_tr_b16 v[44:45], v5 offset:4096
    ds_read_b64_tr_b16 v[46:47], v5 offset:6144
    buffer_load_dwordx4 v236, s[24:27], s78 offen offset:3072 nt lds
    s_waitcnt lgkmcnt(13)
    v_mfma_f32_32x32x16_bf16 v[16:31], v[52:55], v[220:223], v[16:31]
    ds_read_b64_tr_b16 v[52:53], v6 offset:4096
    ds_read_b64_tr_b16 v[54:55], v6 offset:6144
    s_waitcnt lgkmcnt(13)
    v_mfma_f32_32x32x16_bf16 v[16:31], v[60:63], v[228:231], v[16:31]
    ds_read_b64_tr_b16 v[60:61], v7 offset:4096
    ds_read_b64_tr_b16 v[62:63], v7 offset:6144
    s_nop 9
    v_max3_f32 v1, v16, v17, v18
    v_max3_f32 v2, v19, v20, v21
    v_max3_f32 v1, v1, v22, v23
    v_max3_f32 v2, v2, v24, v25
    v_max3_f32 v1, v1, v26, v27
    v_max3_f32 v2, v2, v28, v29
    v_max3_f32 v1, v1, v30, v31
    v_max_f32 v1, v1, v2
    v_fma_f32 v2, v1, s60, -v252
    v_cmp_nge_f32 vcc, s70, v2
    s_nop 0
    s_cbranch_vccnz L_A_R
L_A_C:
    v_fma_f32 v16, v16, s60, -v252
    v_fma_f32 v17, v17, s60, -v252
    v_fma_f32 v18, v18, s60, -v252
    v_fma_f32 v19, v19, s60, -v252
    v_fma_f32 v20, v20, s60, -v252
    v_fma_f32 v21, v21, s60, -v252
    v_fma_f32 v22, v22, s60, -v252
    v_fma_f32 v23, v23, s60, -v252
    v_exp_f32 v16, v16
    v_exp_f32 v17, v17
    v_exp_f32 v18, v18
    v_exp_f32 v19, v19
    v_exp_f32 v20, v20
    v_exp_f32 v21, v21
    v_exp_f32 v22, v22
    v_exp_f32 v23, v23
    s_setpc_b64 s[58:59]
L_A_R:
    v_mov_b32 v2, v1
    s_nop 1
    v_permlane32_swap_b32 v1, v2
    v_max_f32 v1, v1, v2
    v_mul_f32 v1, s60, v1
    v_max_f32 v1, v1, v252
    v_sub_f32 v254, v252, v1
    v_mov_b32 v252, v1
    v_exp_f32 v254, v254
    s_nop 0
    v_mul_f32 v253, v254, v253
    v_mul_f32 v64, v254, v64
    v_mul_f32 v65, v254, v65
    v_mul_f32 v66, v254, v66
    v_mul_f32 v67, v254, v67
    v_mul_f32 v68, v254, v68
    v_mul_f32 v69, v254, v69
    v_mul_f32 v70, v254, v70
    v_mul_f32 v71, v254, v71
    v_mul_f32 v72, v254, v72
    v_mul_f32 v73, v254, v73
    v_mul_f32 v74, v254, v74
    v_mul_f32 v75, v254, v75
    v_mul_f32 v76, v254, v76
    v_mul_f32 v77, v254, v77
    v_mul_f32 v78, v254, v78
    v_mul_f32 v79, v254, v79
    v_mul_f32 v80, v254, v80
    v_mul_f32 v81, v254, v81
    v_mul_f32 v82, v254, v82
    v_mul_f32 v83, v254, v83
    v_mul_f32 v84, v254, v84
    v_mul_f32 v85, v254, v85
    v_mul_f32 v86, v254, v86
    v_mul_f32 v87, v254, v87
    v_mul_f32 v88, v254, v88
    v_mul_f32 v89, v254, v89
    v_mul_f32 v90, v254, v90
    v_mul_f32 v91, v254, v91
    v_mul_f32 v92, v254, v92
    v_mul_f32 v93, v254, v93
    v_mul_f32 v94, v254, v94
    v_mul_f32 v95, v254, v95
    v_mul_f32 v96, v254, v96
    v_mul_f32 v97, v254, v97
    v_mul_f32 v98, v254, v98
    v_mul_f32 v99, v254, v99
    v_mul_f32 v100, v254, v100
    v_mul_f32 v101, v254, v101
    v_mul_f32 v102, v254, v102
    v_mul_f32 v103, v254, v103
    v_mul_f32 v104, v254, v104
    v_mul_f32 v105, v254, v105
    v_mul_f32 v106, v254, v106
    v_mul_f32 v107, v254, v107
    v_mul_f32 v108, v254, v108
    v_mul_f32 v109, v254, v109
    v_mul_f32 v110, v254, v110
    v_mul_f32 v111, v254, v111
    v_mul_f32 v112, v254, v112
    v_mul_f32 v113, v254, v113
    v_mul_f32 v114, v254, v114
    v_mul_f32 v115, v254, v115
    v_mul_f32 v116, v254, v116
    v_mul_f32 v117, v254, v117
    v_mul_f32 v118, v254, v118
    v_mul_f32 v119, v254, v119
    v_mul_f32 v120, v254, v120
    v_mul_f32 v121, v254, v121
    v_mul_f32 v122, v254, v122
    v_mul_f32 v123, v254, v123
    v_mul_f32 v124, v254, v124
    v_mul_f32 v125, v254, v125
    v_mul_f32 v126, v254, v126
    v_mul_f32 v127, v254, v127
    s_branch L_A_C
L_A_NV:
    v_add_u32 v4, s57, v242
    v_xor_b32 v5, 64, v4
    v_xor_b32 v6, 128, v4
    v_xor_b32 v7, 192, v4
    s_add_u32 s57, s57, 32768
    s_cmp_ge_u32 s57, 98304
    s_cselect_b32 s57, 0, s57
    s_waitcnt lgkmcnt(7)
    v_mfma_f32_32x32x16_bf16 v[16:31], v[32:35], v[200:203], 0
    ds_read_b64_tr_b16 v[32:33], v4 offset:0
    ds_read_b64_tr_b16 v[34:35], v4 offset:2048
    s_waitcnt lgkmcnt(8)
    v_mfma_f32_32x32x16_bf16 v[16:31], v[40:43], v[208:211], v[16:31]
    ds_read_b64_tr_b16 v[40:41], v5 offset:0
    ds_read_b64_tr_b16 v[42:43], v5 offset:2048
    s_waitcnt lgkmcnt(9)
    v_mfma_f32_32x32x16_bf16 v[16:31], v[48:51], v[216:219], v[16:31]
    ds_read_b64_tr_b16 v[48:49], v6 offset:0
    ds_read_b64_tr_b16 v[50:51], v6 offset:2048
    s_waitcnt lgkmcnt(10)
    v_mfma_f32_32x32x16_bf16 v[16:31], v[56:59], v[224:227], v[16:31]
    ds_read_b64_tr_b16 v[56:57], v7 offset:0
    ds_read_b64_tr_b16 v[58:59], v7 offset:2048
    s_waitcnt lgkmcnt(11)
    v_mfma_f32_32x32x16_bf16 v[16:31], v[36:39], v[204:207], v[16:31]
    ds_read_b64_tr_b16 v[36:37], v4 offset:4096
    ds_read_b64_tr_b16 v[38:39], v4 offset:6144
    s_waitcnt lgkmcnt(12)
    v_mfma_f32_32x32x16_bf16 v[16:31], v[44:47], v[212:215], v[16:31]
    ds_read_b64_tr_b16 v[44:45], v5 offset:4096
    ds_read_b64_tr_b16 v[46:47], v5 offset:6144
    s_waitcnt lgkmcnt(13)
    v_mfma_f32_32x32x16_bf16 v[16:31], v[52:55], v[220:223], v[16:31]
    ds_read_b64_tr_b16 v[52:53], v6 offset:4096
    ds_read_b64_tr_b16 v[54:55], v6 offset:6144
    s_waitcnt lgkmcnt(13)
    v_mfma_f32_32x32x16_bf16 v[16:31], v[60:63], v[228:231], v[16:31]
    ds_read_b64_tr_b16 v[60:61], v7 offset:4096
    ds_read_b64_tr_b16 v[62:63], v7 offset:6144
    s_nop 9
    v_max3_f32 v1, v16, v17, v18
    v_max3_f32 v2, v19, v20, v21
    v_max3_f32 v1, v1, v22, v23
    v_max3_f32 v2, v2, v24, v25
    v_max3_f32 v1, v1, v26, v27
    v_max3_f32 v2, v2, v28, v29
    v_max3_f32 v1, v1, v30, v31
    v_max_f32 v1, v1, v2
    v_fma_f32 v2, v1, s60, -v252
    v_cmp_nge_f32 vcc, s70, v2
    s_nop 0
    s_cbranch_vccnz L_A_NV_R
L_A_NV_C:
    v_fma_f32 v16, v16, s60, -v252
    v_fma_f32 v17, v17, s60, -v252
    v_fma_f32 v18, v18, s60, -v252
    v_fma_f32 v19, v19, s60, -v252
    v_fma_f32 v20, v20, s60, -v252
    v_fma_f32 v21, v21, s60, -v252
    v_fma_f32 v22, v22, s60, -v252
    v_fma_f32 v23, v23, s60, -v252
    v_exp_f32 v16, v16
    v_exp_f32 v17, v17
    v_exp_f32 v18, v18
    v_exp_f32 v19, v19
    v_exp_f32 v20, v20
    v_exp_f32 v21, v21
    v_exp_f32 v22, v22
    v_exp_f32 v23, v23
    s_setpc_b64 s[58:59]
L_A_NV_R:
    v_mov_b32 v2, v1
    s_nop 1
    v_permlane32_swap_b32 v1, v2
    v_max_f32 v1, v1, v2
    v_mul_f32 v1, s60, v1
    v_max_f32 v1, v1, v252
    v_sub_f32 v254, v252, v1
    v_mov_b32 v252, v1
    v_exp_f32 v254, v254
    s_nop 0
    v_mul_f32 v253, v254, v253
    v_mul_f32 v64, v254, v64
    v_mul_f32 v65, v254, v65
    v_mul_f32 v66, v254, v66
    v_mul_f32 v67, v254, v67
    v_mul_f32 v68, v254, v68
    v_mul_f32 v69, v254, v69
    v_mul_f32 v70, v254, v70
    v_mul_f32 v71, v254, v71
    v_mul_f32 v72, v254, v72
    v_mul_f32 v73, v254, v73
    v_mul_f32 v74, v254, v74
    v_mul_f32 v75, v254, v75
    v_mul_f32 v76, v254, v76
    v_mul_f32 v77, v254, v77
    v_mul_f32 v78, v254, v78
    v_mul_f32 v79, v254, v79
    v_mul_f32 v80, v254, v80
    v_mul_f32 v81, v254, v81
    v_mul_f32 v82, v254, v82
    v_mul_f32 v83, v254, v83
    v_mul_f32 v84, v254, v84
    v_mul_f32 v85, v254, v85
    v_mul_f32 v86, v254, v86
    v_mul_f32 v87, v254, v87
    v_mul_f32 v88, v254, v88
    v_mul_f32 v89, v254, v89
    v_mul_f32 v90, v254, v90
    v_mul_f32 v91, v254, v91
    v_mul_f32 v92, v254, v92
    v_mul_f32 v93, v254, v93
    v_mul_f32 v94, v254, v94
    v_mul_f32 v95, v254, v95
    v_mul_f32 v96, v254, v96
    v_mul_f32 v97, v254, v97
    v_mul_f32 v98, v254, v98
    v_mul_f32 v99, v254, v99
    v_mul_f32 v100, v254, v100
    v_mul_f32 v101, v254, v101
    v_mul_f32 v102, v254, v102
    v_mul_f32 v103, v254, v103
    v_mul_f32 v104, v254, v104
    v_mul_f32 v105, v254, v105
    v_mul_f32 v106, v254, v106
    v_mul_f32 v107, v254, v107
    v_mul_f32 v108, v254, v108
    v_mul_f32 v109, v254, v109
    v_mul_f32 v110, v254, v110
    v_mul_f32 v111, v254, v111
    v_mul_f32 v112, v254, v112
    v_mul_f32 v113, v254, v113
    v_mul_f32 v114, v254, v114
    v_mul_f32 v115, v254, v115
    v_mul_f32 v116, v254, v116
    v_mul_f32 v117, v254, v117
    v_mul_f32 v118, v254, v118
    v_mul_f32 v119, v254, v119
    v_mul_f32 v120, v254, v120
    v_mul_f32 v121, v254, v121
    v_mul_f32 v122, v254, v122
    v_mul_f32 v123, v254, v123
    v_mul_f32 v124, v254, v124
    v_mul_f32 v125, v254, v125
    v_mul_f32 v126, v254, v126
    v_mul_f32 v127, v254, v127
    s_branch L_A_NV_C
L_LAST1:
    v_add_u32 v4, s57, v242
    v_xor_b32 v5, 64, v4
    v_xor_b32 v6, 128, v4
    v_xor_b32 v7, 192, v4
    s_add_u32 s57, s57, 32768
    s_cmp_ge_u32 s57, 98304
    s_cselect_b32 s57, 0, s57
    s_waitcnt lgkmcnt(7)
    v_mfma_f32_32x32x16_bf16 v[16:31], v[32:35], v[200:203], 0
    s_waitcnt lgkmcnt(6)
    v_mfma_f32_32x32x16_bf16 v[16:31], v[40:43], v[208:211], v[16:31]
    s_waitcnt lgkmcnt(5)
    v_mfma_f32_32x32x16_bf16 v[16:31], v[48:51], v[216:219], v[16:31]
    s_waitcnt lgkmcnt(4)
    v_mfma_f32_32x32x16_bf16 v[16:31], v[56:59], v[224:227], v[16:31]
    s_waitcnt lgkmcnt(3)
    v_mfma_f32_32x32x16_bf16 v[16:31], v[36:39], v[204:207], v[16:31]
    s_waitcnt lgkmcnt(2)
    v_mfma_f32_32x32x16_bf16 v[16:31], v[44:47], v[212:215], v[16:31]
    s_waitcnt lgkmcnt(1)
    v_mfma_f32_32x32x16_bf16 v[16:31], v[52:55], v[220:223], v[16:31]
    s_waitcnt lgkmcnt(0)
    v_mfma_f32_32x32x16_bf16 v[16:31], v[60:63], v[228:231], v[16:31]
    s_nop 11
    v_max3_f32 v1, v16, v17, v18
    v_max3_f32 v2, v19, v20, v21
    v_max3_f32 v1, v1, v22, v23
    v_max3_f32 v2, v2, v24, v25
    v_max3_f32 v1, v1, v26, v27
    v_max3_f32 v2, v2, v28, v29
    v_max3_f32 v1, v1, v30, v31
    v_max_f32 v1, v1, v2
    v_fma_f32 v2, v1, s60, -v252
    v_cmp_nge_f32 vcc, s70, v2
    s_nop 0
    s_cbranch_vccnz L_LAST1_R
L_LAST1_C:
    v_fma_f32 v16, v16, s60, -v252
    v_fma_f32 v17, v17, s60, -v252
    v_fma_f32 v18, v18, s60, -v252
    v_fma_f32 v19, v19, s60, -v252
    v_fma_f32 v20, v20, s60, -v252
    v_fma_f32 v21, v21, s60, -v252
    v_fma_f32 v22, v22, s60, -v252
    v_fma_f32 v23, v23, s60, -v252
    v_exp_f32 v16, v16
    v_exp_f32 v17, v17
    v_exp_f32 v18, v18
    v_exp_f32 v19, v19
    v_exp_f32 v20, v20
    v_exp_f32 v21, v21
    v_exp_f32 v22, v22
    v_exp_f32 v23, v23
    v_fma_f32 v24, v24, s60, -v252
    v_fma_f32 v25, v25, s60, -v252
    v_fma_f32 v26, v26, s60, -v252
    v_fma_f32 v27, v27, s60, -v252
    v_fma_f32 v28, v28, s60, -v252
    v_fma_f32 v29, v29, s60, -v252
    v_fma_f32 v30, v30, s60, -v252
    v_fma_f32 v31, v31, s60, -v252
    v_exp_f32 v24, v24
    v_exp_f32 v25, v25
    v_exp_f32 v26, v26
    v_exp_f32 v27, v27
    v_exp_f32 v28, v28
    v_exp_f32 v29, v29
    v_exp_f32 v30, v30
    v_exp_f32 v31, v31
    v_add_f32 v1, v16, v17
    v_add_f32 v2, v18, v19
    v_cvt_pk_bf16_f32 v8, v16, v17
    v_cvt_pk_bf16_f32 v9, v18, v19
    v_cvt_pk_bf16_f32 v10, v20, v21
    v_cvt_pk_bf16_f32 v11, v22, v23
    v_cvt_pk_bf16_f32 v12, v24, v25
    v_cvt_pk_bf16_f32 v13, v26, v27
    v_cvt_pk_bf16_f32 v14, v28, v29
    v_cvt_pk_bf16_f32 v15, v30, v31
    v_add_f32 v1, v1, v20
    v_add_f32 v2, v2, v21
    v_add_f32 v1, v1, v22
    v_add_f32 v2, v2, v23
    v_add_f32 v1, v1, v24
    v_add_f32 v2, v2, v25
    v_add_f32 v1, v1, v26
    v_add_f32 v2, v2, v27
    v_add_f32 v1, v1, v28
    v_add_f32 v2, v2, v29
    v_add_f32 v1, v1, v30
    v_add_f32 v2, v2, v31
    v_add_f32 v253, v253, v1
    v_add_f32 v253, v253, v2
    s_setpc_b64 s[58:59]
L_LAST1_R:
    v_mov_b32 v2, v1
    s_nop 1
    v_permlane32_swap_b32 v1, v2
    v_max_f32 v1, v1, v2
    v_mul_f32 v1, s60, v1
    v_max_f32 v1, v1, v252
    v_sub_f32 v254, v252, v1
    v_mov_b32 v252, v1
    v_exp_f32 v254, v254
    s_nop 0
    v_mul_f32 v253, v254, v253
    v_mul_f32 v64, v254, v64
    v_mul_f32 v65, v254, v65
    v_mul_f32 v66, v254, v66
    v_mul_f32 v67, v254, v67
    v_mul_f32 v68, v254, v68
    v_mul_f32 v69, v254, v69
    v_mul_f32 v70, v254, v70
    v_mul_f32 v71, v254, v71
    v_mul_f32 v72, v254, v72
    v_mul_f32 v73, v254, v73
    v_mul_f32 v74, v254, v74
    v_mul_f32 v75, v254, v75
    v_mul_f32 v76, v254, v76
    v_mul_f32 v77, v254, v77
    v_mul_f32 v78, v254, v78
    v_mul_f32 v79, v254, v79
    v_mul_f32 v80, v254, v80
    v_mul_f32 v81, v254, v81
    v_mul_f32 v82, v254, v82
    v_mul_f32 v83, v254, v83
    v_mul_f32 v84, v254, v84
    v_mul_f32 v85, v254, v85
    v_mul_f32 v86, v254, v86
    v_mul_f32 v87, v254, v87
    v_mul_f32 v88, v254, v88
    v_mul_f32 v89, v254, v89
    v_mul_f32 v90, v254, v90
    v_mul_f32 v91, v254, v91
    v_mul_f32 v92, v254, v92
    v_mul_f32 v93, v254, v93
    v_mul_f32 v94, v254, v94
    v_mul_f32 v95, v254, v95
    v_mul_f32 v96, v254, v96
    v_mul_f32 v97, v254, v97
    v_mul_f32 v98, v254, v98
    v_mul_f32 v99, v254, v99
    v_mul_f32 v100, v254, v100
    v_mul_f32 v101, v254, v101
    v_mul_f32 v102, v254, v102
    v_mul_f32 v103, v254, v103
    v_mul_f32 v104, v254, v104
    v_mul_f32 v105, v254, v105
    v_mul_f32 v106, v254, v106
    v_mul_f32 v107, v254, v107
    v_mul_f32 v108, v254, v108
    v_mul_f32 v109, v254, v109
    v_mul_f32 v110, v254, v110
    v_mul_f32 v111, v254, v111
    v_mul_f32 v112, v254, v112
    v_mul_f32 v113, v254, v113
    v_mul_f32 v114, v254, v114
    v_mul_f32 v115, v254, v115
    v_mul_f32 v116, v254, v116
    v_mul_f32 v117, v254, v117
    v_mul_f32 v118, v254, v118
    v_mul_f32 v119, v254, v119
    v_mul_f32 v120, v254, v120
    v_mul_f32 v121, v254, v121
    v_mul_f32 v122, v254, v122
    v_mul_f32 v123, v254, v123
    v_mul_f32 v124, v254, v124
    v_mul_f32 v125, v254, v125
    v_mul_f32 v126, v254, v126
    v_mul_f32 v127, v254, v127
    s_branch L_LAST1_C
L_B:
    s_mov_b32 m0, s56
    s_nop 0
    buffer_load_dwordx4 v232, s[20:23], s55 offen offset:0 nt lds
    v_cvt_pk_bf16_f32 v8, v16, v17
    v_cvt_pk_bf16_f32 v9, v18, v19
    v_cvt_pk_bf16_f32 v10, v20, v21
    v_cvt_pk_bf16_f32 v11, v22, v23
    v_fma_f32 v24, v24, s60, -v252
    v_fma_f32 v25, v25, s60, -v252
    v_fma_f32 v26, v26, s60, -v252
    v_fma_f32 v27, v27, s60, -v252
    v_mfma_f32_32x32x16_bf16 v[64:79], v[32:35], v[8:11], v[64:79]
    buffer_load_dwordx4 v233, s[20:23], s55 offen offset:1024 nt lds
    v_fma_f32 v28, v28, s60, -v252
    v_fma_f32 v29, v29, s60, -v252
    v_fma_f32 v30, v30, s60, -v252
    v_fma_f32 v31, v31, s60, -v252
    v_add_u32 v255, s57, v241
    ds_read_b128 v[32:35], v255
    v_mfma_f32_32x32x16_bf16 v[80:95], v[40:43], v[8:11], v[80:95]
    buffer_load_dwordx4 v234, s[20:23], s55 offen offset:2048 nt lds
    v_exp_f32 v24, v24
    v_exp_f32 v25, v25
    v_exp_f32 v26, v26
    v_xor_b32 v3, 64, v255
    ds_read_b128 v[40:43], v3
    v_mfma_f32_32x32x16_bf16 v[96:111], v[48:51], v[8:11], v[96:111]
    buffer_load_dwordx4 v235, s[20:23], s55 offen offset:3072 nt lds
    v_exp_f32 v27, v27
    v_exp_f32 v28, v28
    v_exp_f32 v29, v29
    v_xor_b32 v3, 128, v255
    ds_read_b128 v[48:51], v3
    v_mfma_f32_32x32x16_bf16 v[112:127], v[56:59], v[8:11], v[112:127]
    v_exp_f32 v30, v30
    v_exp_f32 v31, v31
    v_xor_b32 v3, 192, v255
    ds_read_b128 v[56:59], v3
    v_cvt_pk_bf16_f32 v12, v24, v25
    v_cvt_pk_bf16_f32 v13, v26, v27
    v_cvt_pk_bf16_f32 v14, v28, v29
    v_cvt_pk_bf16_f32 v15, v30, v31
    v_add_f32 v1, v16, v17
    v_add_f32 v2, v18, v19
    v_mfma_f32_32x32x16_bf16 v[64:79], v[36:39], v[12:15], v[64:79]
    v_add_f32 v1, v1, v20
    v_add_f32 v2, v2, v21
    v_add_f32 v1, v1, v22
    v_add_f32 v2, v2, v23
    v_xor_b32 v3, 32, v255
    ds_read_b128 v[36:39], v3
    v_mfma_f32_32x32x16_bf16 v[80:95], v[44:47], v[12:15], v[80:95]
    v_add_f32 v1, v1, v24
    v_add_f32 v2, v2, v25
    v_add_f32 v1, v1, v26
    v_add_f32 v2, v2, v27
    v_xor_b32 v3, 96, v255
    ds_read_b128 v[44:47], v3
    v_mfma_f32_32x32x16_bf16 v[96:111], v[52:55], v[12:15], v[96:111]
    v_add_f32 v1, v1, v28
    v_add_f32 v2, v2, v29
    v_add_f32 v1, v1, v30
    v_add_f32 v2, v2, v31
    v_xor_b32 v3, 160, v255
    ds_read_b128 v[52:55], v3
    v_mfma_f32_32x32x16_bf16 v[112:127], v[60:63], v[12:15], v[112:127]
    v_add_f32 v253, v253, v1
    v_add_f32 v253, v253, v2
    v_xor_b32 v3, 224, v255
    ds_read_b128 v[60:63], v3
    s_mov_b32 s78, s55
    s_add_u32 s79, s56, 16384
    s_add_u32 s55, s55, 16384
    s_add_u32 s56, s56, 32768
    s_cmp_ge_u32 s56, 98304
    s_cselect_b32 s64, 98304, 0
    s_sub_u32 s56, s56, s64
    s_setpc_b64 s[58:59]
L_B_N:
    v_cvt_pk_bf16_f32 v8, v16, v17
    v_cvt_pk_bf16_f32 v9, v18, v19
    v_cvt_pk_bf16_f32 v10, v20, v21
    v_cvt_pk_bf16_f32 v11, v22, v23
    v_fma_f32 v24, v24, s60, -v252
    v_fma_f32 v25, v25, s60, -v252
    v_fma_f32 v26, v26, s60, -v252
    v_fma_f32 v27, v27, s60, -v252
    v_mfma_f32_32x32x16_bf16 v[64:79], v[32:35], v[8:11], v[64:79]
    v_fma_f32 v28, v28, s60, -v252
    v_fma_f32 v29, v29, s60, -v252
    v_fma_f32 v30, v30, s60, -v252
    v_fma_f32 v31, v31, s60, -v252
    v_add_u32 v255, s57, v241
    ds_read_b128 v[32:35], v255
    v_mfma_f32_32x32x16_bf16 v[80:95], v[40:43], v[8:11], v[80:95]
    v_exp_f32 v24, v24
    v_exp_f32 v25, v25
    v_exp_f32 v26, v26
    v_xor_b32 v3, 64, v255
    ds_read_b128 v[40:43], v3
    v_mfma_f32_32x32x16_bf16 v[96:111], v[48:51], v[8:11], v[96:111]
    v_exp_f32 v27, v27
    v_exp_f32 v28, v28
    v_exp_f32 v29, v29
    v_xor_b32 v3, 128, v255
    ds_read_b128 v[48:51], v3
    v_mfma_f32_32x32x16_bf16 v[112:127], v[56:59], v[8:11], v[112:127]
    v_exp_f32 v30, v30
    v_exp_f32 v31, v31
    v_xor_b32 v3, 192, v255
    ds_read_b128 v[56:59], v3
    v_cvt_pk_bf16_f32 v12, v24, v25
    v_cvt_pk_bf16_f32 v13, v26, v27
    v_cvt_pk_bf16_f32 v14, v28, v29
    v_cvt_pk_bf16_f32 v15, v30, v31
    v_add_f32 v1, v16, v17
    v_add_f32 v2, v18, v19
    v_mfma_f32_32x32x16_bf16 v[64:79], v[36:39], v[12:15], v[64:79]
    v_add_f32 v1, v1, v20
    v_add_f32 v2, v2, v21
    v_add_f32 v1, v1, v22
    v_add_f32 v2, v2, v23
    v_xor_b32 v3, 32, v255
    ds_read_b128 v[36:39], v3
    v_mfma_f32_32x32x16_bf16 v[80:95], v[44:47], v[12:15], v[80:95]
    v_add_f32 v1, v1, v24
    v_add_f32 v2, v2, v25
    v_add_f32 v1, v1, v26
    v_add_f32 v2, v2, v27
    v_xor_b32 v3, 96, v255
    ds_read_b128 v[44:47], v3
    v_mfma_f32_32x32x16_bf16 v[96:111], v[52:55], v[12:15], v[96:111]
    v_add_f32 v1, v1, v28
    v_add_f32 v2, v2, v29
    v_add_f32 v1, v1, v30
    v_add_f32 v2, v2, v31
    v_xor_b32 v3, 160, v255
    ds_read_b128 v[52:55], v3
    v_mfma_f32_32x32x16_bf16 v[112:127], v[60:63], v[12:15], v[112:127]
    v_add_f32 v253, v253, v1
    v_add_f32 v253, v253, v2
    v_xor_b32 v3, 224, v255
    ds_read_b128 v[60:63], v3
    s_setpc_b64 s[58:59]
L_LAST2:
    ds_read_b64_tr_b16 v[48:49], v6 offset:0
    ds_read_b64_tr_b16 v[50:51], v6 offset:2048
    ds_read_b64_tr_b16 v[52:53], v6 offset:4096
    ds_read_b64_tr_b16 v[54:55], v6 offset:6144
    ds_read_b64_tr_b16 v[56:57], v7 offset:0
    ds_read_b64_tr_b16 v[58:59], v7 offset:2048
    ds_read_b64_tr_b16 v[60:61], v7 offset:4096
    ds_read_b64_tr_b16 v[62:63], v7 offset:6144
    ds_read_b64_tr_b16 v[32:33], v4 offset:0
    ds_read_b64_tr_b16 v[34:35], v4 offset:2048
    ds_read_b64_tr_b16 v[36:37], v4 offset:4096
    ds_read_b64_tr_b16 v[38:39], v4 offset:6144
    s_waitcnt lgkmcnt(10)
    v_mfma_f32_32x32x16_bf16 v[96:111], v[48:51], v[8:11], v[96:111]
    ds_read_b64_tr_b16 v[40:41], v5 offset:0
    ds_read_b64_tr_b16 v[42:43], v5 offset:2048
    ds_read_b64_tr_b16 v[44:45], v5 offset:4096
    ds_read_b64_tr_b16 v[46:47], v5 offset:6144
    s_waitcnt lgkmcnt(12)
    v_mfma_f32_32x32x16_bf16 v[96:111], v[52:55], v[12:15], v[96:111]
    s_waitcnt lgkmcnt(10)
    v_mfma_f32_32x32x16_bf16 v[112:127], v[56:59], v[8:11], v[112:127]
    s_waitcnt lgkmcnt(8)
    v_mfma_f32_32x32x16_bf16 v[112:127], v[60:63], v[12:15], v[112:127]
    s_waitcnt lgkmcnt(6)
    v_mfma_f32_32x32x16_bf16 v[64:79], v[32:35], v[8:11], v[64:79]
    s_waitcnt lgkmcnt(4)
    v_mfma_f32_32x32x16_bf16 v[64:79], v[36:39], v[12:15], v[64:79]
    s_waitcnt lgkmcnt(2)
    v_mfma_f32_32x32x16_bf16 v[80:95], v[40:43], v[8:11], v[80:95]
    s_waitcnt lgkmcnt(0)
    v_mfma_f32_32x32x16_bf16 v[80:95], v[44:47], v[12:15], v[80:95]
    s_setpc_b64 s[58:59]
L_FIN:
    v_mov_b32 v2, v253
    v_lshl_add_u32 v1, v0, 4, s96
    s_nop 0
    v_permlane32_swap_b32 v253, v2
    v_add_f32 v253, v253, v2
    ds_write_b64 v1, v[252:253] offset:8192
    ds_write_b128 v1, v[96:99] offset:0
    ds_write_b128 v1, v[100:103] offset:1024
    ds_write_b128 v1, v[104:107] offset:2048
    ds_write_b128 v1, v[108:111] offset:3072
    s_nop 3
    ds_write_b128 v1, v[112:115] offset:4096
    ds_write_b128 v1, v[116:119] offset:5120
    ds_write_b128 v1, v[120:123] offset:6144
    ds_write_b128 v1, v[124:127] offset:7168
    v_lshl_add_u32 v1, v0, 4, s97
    v_bfe_u32 v2, v0, 4, 1
    v_lshlrev_b32 v2, 10, v2
    v_and_b32 v3, 15, v0
    v_lshl_add_u32 v2, v3, 4, v2
    s_add_u32 s64, s71, 135168
    v_lshrrev_b32 v3, 5, v0
    v_lshlrev_b32 v3, 8, v3
    v_add3_u32 v2, v2, v3, s64
    s_waitcnt lgkmcnt(0)
    s_barrier
    ds_read_b64 v[4:5], v1 offset:8192
    ds_read_b128 v[96:99], v1 offset:0
    ds_read_b128 v[100:103], v1 offset:1024
    ds_read_b128 v[104:107], v1 offset:2048
    ds_read_b128 v[108:111], v1 offset:3072
    ds_read_b128 v[112:115], v1 offset:4096
    ds_read_b128 v[116:119], v1 offset:5120
    ds_read_b128 v[120:123], v1 offset:6144
    ds_read_b128 v[124:127], v1 offset:7168
    s_waitcnt lgkmcnt(8)
    v_max_f32 v3, v252, v4
    v_sub_f32 v6, v252, v3
    v_sub_f32 v7, v4, v3
    v_exp_f32 v6, v6
    v_exp_f32 v7, v7
    s_nop 0
    v_mul_f32 v3, v253, v6
    v_fma_f32 v3, v5, v7, v3
    v_rcp_f32 v3, v3
    s_nop 0
    v_mul_f32 v6, v6, v3
    v_mul_f32 v7, v7, v3
    v_pk_mul_f32 v[64:65], v[64:65], v[6:7] op_sel_hi:[1,0]
    v_pk_mul_f32 v[66:67], v[66:67], v[6:7] op_sel_hi:[1,0]
    v_pk_mul_f32 v[68:69], v[68:69], v[6:7] op_sel_hi:[1,0]
    v_pk_mul_f32 v[70:71], v[70:71], v[6:7] op_sel_hi:[1,0]
    v_pk_mul_f32 v[72:73], v[72:73], v[6:7] op_sel_hi:[1,0]
    v_pk_mul_f32 v[74:75], v[74:75], v[6:7] op_sel_hi:[1,0]
    v_pk_mul_f32 v[76:77], v[76:77], v[6:7] op_sel_hi:[1,0]
    v_pk_mul_f32 v[78:79], v[78:79], v[6:7] op_sel_hi:[1,0]
    v_pk_mul_f32 v[80:81], v[80:81], v[6:7] op_sel_hi:[1,0]
    v_pk_mul_f32 v[82:83], v[82:83], v[6:7] op_sel_hi:[1,0]
    v_pk_mul_f32 v[84:85], v[84:85], v[6:7] op_sel_hi:[1,0]
    v_pk_mul_f32 v[86:87], v[86:87], v[6:7] op_sel_hi:[1,0]
    v_pk_mul_f32 v[88:89], v[88:89], v[6:7] op_sel_hi:[1,0]
    v_pk_mul_f32 v[90:91], v[90:91], v[6:7] op_sel_hi:[1,0]
    v_pk_mul_f32 v[92:93], v[92:93], v[6:7] op_sel_hi:[1,0]
    v_pk_mul_f32 v[94:95], v[94:95], v[6:7] op_sel_hi:[1,0]
    s_waitcnt lgkmcnt(4)
    v_pk_fma_f32 v[64:65], v[96:97], v[6:7], v[64:65] op_sel:[0,1,0] op_sel_hi:[1,1,1]
    v_pk_fma_f32 v[66:67], v[98:99], v[6:7], v[66:67] op_sel:[0,1,0] op_sel_hi:[1,1,1]
    v_pk_fma_f32 v[68:69], v[100:101], v[6:7], v[68:69] op_sel:[0,1,0] op_sel_hi:[1,1,1]
    v_pk_fma_f32 v[70:71], v[102:103], v[6:7], v[70:71] op_sel:[0,1,0] op_sel_hi:[1,1,1]
    v_pk_fma_f32 v[72:73], v[104:105], v[6:7], v[72:73] op_sel:[0,1,0] op_sel_hi:[1,1,1]
    v_pk_fma_f32 v[74:75], v[106:107], v[6:7], v[74:75] op_sel:[0,1,0] op_sel_hi:[1,1,1]
    v_pk_fma_f32 v[76:77], v[108:109], v[6:7], v[76:77] op_sel:[0,1,0] op_sel_hi:[1,1,1]
    v_pk_fma_f32 v[78:79], v[110:111], v[6:7], v[78:79] op_sel:[0,1,0] op_sel_hi:[1,1,1]
    v_cvt_pk_bf16_f32 v96, v64, v65
    v_cvt_pk_bf16_f32 v97, v66, v67
    v_cvt_pk_bf16_f32 v98, v72, v73
    v_cvt_pk_bf16_f32 v99, v74, v75
    v_cvt_pk_bf16_f32 v100, v68, v69
    v_cvt_pk_bf16_f32 v101, v70, v71
    v_cvt_pk_bf16_f32 v102, v76, v77
    v_cvt_pk_bf16_f32 v103, v78, v79
    ds_write_b128 v2, v[96:99] offset:0
    ds_write_b128 v2, v[100:103] offset:512
    s_waitcnt lgkmcnt(2)
    v_pk_fma_f32 v[80:81], v[112:113], v[6:7], v[80:81] op_sel:[0,1,0] op_sel_hi:[1,1,1]
    v_pk_fma_f32 v[82:83], v[114:115], v[6:7], v[82:83] op_sel:[0,1,0] op_sel_hi:[1,1,1]
    v_pk_fma_f32 v[84:85], v[116:117], v[6:7], v[84:85] op_sel:[0,1,0] op_sel_hi:[1,1,1]
    v_pk_fma_f32 v[86:87], v[118:119], v[6:7], v[86:87] op_sel:[0,1,0] op_sel_hi:[1,1,1]
    v_pk_fma_f32 v[88:89], v[120:121], v[6:7], v[88:89] op_sel:[0,1,0] op_sel_hi:[1,1,1]
    v_pk_fma_f32 v[90:91], v[122:123], v[6:7], v[90:91] op_sel:[0,1,0] op_sel_hi:[1,1,1]
    v_pk_fma_f32 v[92:93], v[124:125], v[6:7], v[92:93] op_sel:[0,1,0] op_sel_hi:[1,1,1]
    v_pk_fma_f32 v[94:95], v[126:127], v[6:7], v[94:95] op_sel:[0,1,0] op_sel_hi:[1,1,1]
    v_cvt_pk_bf16_f32 v104, v80, v81
    v_cvt_pk_bf16_f32 v105, v82, v83
    v_cvt_pk_bf16_f32 v106, v88, v89
    v_cvt_pk_bf16_f32 v107, v90, v91
    v_cvt_pk_bf16_f32 v108, v84, v85
    v_cvt_pk_bf16_f32 v109, v86, v87
    v_cvt_pk_bf16_f32 v110, v92, v93
    v_cvt_pk_bf16_f32 v111, v94, v95
    ds_write_b128 v2, v[104:107] offset:2048
    ds_write_b128 v2, v[108:111] offset:2560
    s_setpc_b64 s[58:59]
.section .rodata,"a"
.p2align 6
.amdhsa_kernel standalone__gqa_block_cached__sampling_kernel
  .amdhsa_next_free_vgpr 512
  .amdhsa_next_free_sgpr 102
  .amdhsa_accum_offset 256
  .amdhsa_group_segment_fixed_size 0
  .amdhsa_kernarg_size 64
  .amdhsa_user_sgpr_count 2
  .amdhsa_user_sgpr_kernarg_segment_ptr 1
  .amdhsa_system_sgpr_workgroup_id_x 1
.end_amdhsa_kernel
```
